```python
import torch

def _softmax(x, axis=-1):
    return torch.softmax(x, dim=axis)
def _gelu(x):
    return torch.nn.functional.gelu(x, approximate="tanh")
def _silu(x):
    return torch.nn.functional.silu(x)
def _sigmoid(x):
    return torch.sigmoid(x)
def _layernorm(x, axis=-1, eps=1e-5):
    m = x.mean(dim=axis, keepdim=True)
    v = x.var(dim=axis, keepdim=True, unbiased=False)
    return (x - m) / torch.sqrt(v + eps)
def _scatter_add(tgt, idx, src, axis=0):
    return tgt.clone().index_add_(axis, idx, src)
def _segment_sum(src, seg, n):
    out = torch.zeros((n,) + src.shape[1:], dtype=src.dtype)
    return out.index_add_(0, seg, src)
def _pad(x, pw):
    flat = tuple(v for pair in reversed(pw) for v in pair)
    return torch.nn.functional.pad(x, flat)

kernel_name = 'standalone__gqa_softmax__near_ridge'

def setup_inputs():

    _w = (lambda a: (lambda t: t.to(torch.bfloat16) if t.is_floating_point() else t)(torch.as_tensor(a)))
    B, Hq, Hkv, Sq, Sk, D = 8, 32, 8, 64, 1024, 128
    return {
        "q": _w((lambda *s: torch.randn(*s, dtype=torch.bfloat16) * 0.8)(B, Hq, Sq, D)),
        "k": _w((lambda *s: torch.randn(*s, dtype=torch.bfloat16) * 0.8)(B, Hkv, Sk, D)),
        "v": _w((lambda *s: torch.randn(*s, dtype=torch.bfloat16) * 0.05)(B, Hkv, Sk, D)),
    }

def reference(q, k, v):
    B, Hq, Sq, D = q.shape
    Hkv = k.shape[1]
    rep = Hq // Hkv
    k = (lambda x, n, axis: torch.repeat_interleave(x, n, dim=axis))(k, rep, axis=1)
    v = (lambda x, n, axis: torch.repeat_interleave(x, n, dim=axis))(v, rep, axis=1)
    scale = D ** -0.5
    scores = torch.einsum("bhqd,bhkd->bhqk", q, k) * scale
    p = _softmax(scores, axis=-1)
    return torch.einsum("bhqk,bhkd->bhqd", p, v)
```

```asm
; @launch grid=(256,1,1) block=(256,1,1) lds=163840
.amdgcn_target "amdgcn-amd-amdhsa--gfx950"
.text
.globl standalone__gqa_softmax__near_ridge_kernel
.p2align 12
.fill 832, 4, 0xbf810000
.p2align 8
.type standalone__gqa_softmax__near_ridge_kernel,@function
standalone__gqa_softmax__near_ridge_kernel:
    s_load_dwordx2 s[12:13], s[0:1], 0
    s_load_dwordx2 s[28:29], s[0:1], 8
    s_load_dwordx2 s[32:33], s[0:1], 16
    s_load_dwordx2 s[36:37], s[0:1], 24
    s_lshr_b32 s3, s2, 8
    s_cbranch_scc1 L_end
    v_lshrrev_b32 v1, 6, v0
    v_and_b32 v0, 63, v0
    v_readfirstlane_b32 s20, v1
    s_and_b32 s21, s2, 7
    s_lshl_b32 s21, s21, 5
    s_lshr_b32 s22, s2, 3
    s_add_u32 s21, s21, s22
    v_lshlrev_b32 v4, 4, v0
    v_and_b32 v5, 48, v0
    v_xor_b32 v108, v4, v5
    v_lshlrev_b32 v6, 2, v5
    v_xor_b32 v109, 64, v108
    v_xor_b32 v110, 128, v108
    v_xor_b32 v112, v4, v6
    v_xor_b32 v111, 64, v110
    s_lshl_b32 s26, s20, 13
    s_mul_i32 s25, s26, 5
    s_lshl2_add_u32 s27, s21, s20
    s_lshl_b32 s27, s27, 12
    s_andn2_b32 s23, s21, 3
    s_lshl_b32 s23, s23, 16
    s_add_u32 s26, s26, s23
    s_bitcmp1_b32 s2, 3
    s_mov_b32 s44, 0x75634120
    s_cselect_b32 s44, 0x75634128, s44
    s_mov_b32 s45, 0x67452301
    s_cselect_b32 s45, 0x67452309, s45
    s_bitcmp1_b32 s2, 4
    s_cselect_b32 s44, s45, s44
    s_movk_i32 s3, 0x1000
    s_and_b32 s41, s44, 8
    s_lshl_b32 s41, s41, 9
    s_add_u32 s42, s25, s41
    s_xor_b32 s43, s42, s3
    s_add_u32 s41, s41, s26
    s_bfe_u32 s45, s44, 0x30004
    s_lshl_b32 s45, s45, 15
    s_add_u32 s47, s45, s41
    s_xor_b32 s55, s47, s3
    s_and_b32 s45, s44, 7
    s_lshl_b32 s45, s45, 15
    s_add_u32 s46, s45, s41
    s_xor_b32 s54, s46, s3
    s_lshl_b32 s14, 1, 22
    s_lshl_b32 s15, 1, 17
    s_lshl_b32 s30, 1, 24
    s_mov_b32 s31, s15
    s_mov_b64 s[34:35], s[30:31]
    s_mov_b64 s[38:39], s[14:15]
    s_mov_b32 s40, 0
    s_waitcnt lgkmcnt(0)
L_restart:
    buffer_load_dwordx4 v[128:131], v4, s[12:15], s27 offen offset:0
    buffer_load_dwordx4 v[132:135], v4, s[12:15], s27 offen offset:1024
    buffer_load_dwordx4 v[136:139], v4, s[12:15], s27 offen offset:2048
    buffer_load_dwordx4 v[140:143], v4, s[12:15], s27 offen offset:3072
    s_mov_b32 m0, s42
    s_nop 0
    buffer_load_dwordx4 v108, s[28:31], s47 offen offset:0  lds
    buffer_load_dwordx4 v109, s[28:31], s47 offen offset:1024  lds
    buffer_load_dwordx4 v110, s[28:31], s47 offen offset:2048  lds
    buffer_load_dwordx4 v111, s[28:31], s47 offen offset:3072  lds
    s_add_u32 m0, s42, 8192
    s_nop 0
    buffer_load_dwordx4 v108, s[28:31], s46 offen offset:0  lds
    buffer_load_dwordx4 v109, s[28:31], s46 offen offset:1024  lds
    buffer_load_dwordx4 v110, s[28:31], s46 offen offset:2048  lds
    buffer_load_dwordx4 v111, s[28:31], s46 offen offset:3072  lds
    s_bfe_u32 s45, s44, 0x30008
    s_lshl_b32 s45, s45, 15
    s_add_u32 s48, s45, s41
    s_xor_b32 s56, s48, s3
    s_bfe_u32 s45, s44, 0x3000c
    s_lshl_b32 s45, s45, 15
    s_add_u32 s49, s45, s41
    s_xor_b32 s57, s49, s3
    s_bfe_u32 s45, s44, 0x30010
    s_lshl_b32 s45, s45, 15
    s_add_u32 s50, s45, s41
    s_xor_b32 s58, s50, s3
    s_bfe_u32 s45, s44, 0x30014
    s_lshl_b32 s45, s45, 15
    s_add_u32 s51, s45, s41
    s_xor_b32 s59, s51, s3
    s_bfe_u32 s45, s44, 0x30018
    s_lshl_b32 s45, s45, 15
    s_add_u32 s52, s45, s41
    s_xor_b32 s60, s52, s3
    s_bfe_u32 s45, s44, 0x3001c
    s_lshl_b32 s45, s45, 15
    s_add_u32 s53, s45, s41
    s_xor_b32 s61, s53, s3
    s_lshl_b32 s24, s21, 14
    s_cmp_eq_u32 s40, 0
    s_cbranch_scc0 L_keepm
    v_mov_b32 v118, 0xff800000
    v_mov_b32 v119, v118
L_keepm:
    v_lshrrev_b32 v2, 4, v0
    v_and_b32 v3, 15, v0
    v_and_b32 v8, 31, v0
    v_lshrrev_b32 v9, 5, v0
    v_xor_b32 v10, v9, v3
    v_lshlrev_b32 v11, 8, v8
    v_lshl_add_u32 v7, v10, 4, v11
    v_add_u32 v96, s25, v7
    v_add_u32 v144, 32768, v7
    v_xor_b32 v97, 32, v96
    v_xor_b32 v98, 64, v96
    v_xor_b32 v100, 128, v96
    v_xor_b32 v99, 32, v98
    v_xor_b32 v101, 32, v100
    v_xor_b32 v102, 64, v100
    v_xor_b32 v103, 32, v102
    v_xor_b32 v145, 32, v144
    v_xor_b32 v146, 64, v144
    v_xor_b32 v148, 128, v144
    v_xor_b32 v147, 32, v146
    v_xor_b32 v149, 32, v148
    v_xor_b32 v150, 64, v148
    v_xor_b32 v151, 32, v150
    v_lshrrev_b32 v7, 2, v3
    v_lshl_add_u32 v13, v9, 2, v7
    v_lshlrev_b32 v13, 8, v13
    v_and_b32 v14, 1, v0
    v_lshl_add_u32 v13, v14, 3, v13
    v_and_b32 v14, 1, v2
    v_lshlrev_b32 v14, 1, v14
    v_bfe_u32 v15, v0, 1, 1
    v_add_u32 v14, v14, v15
    v_xor_b32 v7, s20, v7
    v_lshl_add_u32 v14, v7, 2, v14
    v_lshl_add_u32 v13, v14, 4, v13
    v_add_u32 v104, s25, v13
    v_xor_b32 v105, 64, v104
    v_xor_b32 v106, 128, v104
    v_xor_b32 v107, 64, v106
    s_lshr_b32 s16, s20, 1
    s_mul_i32 s16, s16, 40960
    s_and_b32 s17, s20, 1
    s_lshl_b32 s17, s17, 12
    s_add_u32 s16, s16, s17
    s_add_u32 s16, s16, 32768
    v_add_u32 v160, s16, v108
    v_add_u32 v161, s16, v109
    v_add_u32 v162, s16, v110
    v_add_u32 v163, s16, v111
    s_mov_b32 s18, 0x3e0293ee
    s_mov_b32 s19, 0xffff0000
    v_mov_b32 v113, 0
    v_mov_b32 v114, 0
    v_add_u32 v120, s25, v4
    s_xor_b32 s17, s20, 1
    s_mul_i32 s17, s17, 40960
    v_add_u32 v121, s17, v4
    v_add_u32 v125, s17, v13
    s_xor_b32 s17, s20, 2
    s_mul_i32 s17, s17, 40960
    v_add_u32 v122, s17, v4
    v_add_u32 v126, s17, v13
    s_xor_b32 s17, s20, 3
    s_mul_i32 s17, s17, 40960
    v_add_u32 v123, s17, v4
    v_add_u32 v127, s17, v13
    v_lshl_add_u32 v124, v9, 4, v11
    s_lshl_b32 s17, s20, 6
    v_add_u32 v124, s17, v124
    s_add_u32 s23, s24, 8192
    s_waitcnt vmcnt(11)
    v_lshlrev_b32 v164, 16, v128
    v_and_b32 v165, s19, v128
    v_lshlrev_b32 v166, 16, v129
    v_and_b32 v167, s19, v129
    v_lshlrev_b32 v168, 16, v130
    v_and_b32 v169, s19, v130
    v_lshlrev_b32 v170, 16, v131
    v_and_b32 v171, s19, v131
    v_pk_mul_f32 v[164:165], v[164:165], s[18:19] op_sel_hi:[1,0]
    v_pk_mul_f32 v[166:167], v[166:167], s[18:19] op_sel_hi:[1,0]
    v_pk_mul_f32 v[168:169], v[168:169], s[18:19] op_sel_hi:[1,0]
    v_pk_mul_f32 v[170:171], v[170:171], s[18:19] op_sel_hi:[1,0]
    v_cvt_pk_bf16_f32 v128, v164, v165
    v_cvt_pk_bf16_f32 v129, v166, v167
    v_cvt_pk_bf16_f32 v130, v168, v169
    v_cvt_pk_bf16_f32 v131, v170, v171
    s_add_u32 m0, s43, 8192
    ds_write_b128 v160, v[128:131] offset:0
    buffer_load_dwordx4 v108, s[28:31], s54 offen offset:0  lds
    s_waitcnt vmcnt(11)
    v_lshlrev_b32 v164, 16, v132
    v_and_b32 v165, s19, v132
    v_lshlrev_b32 v166, 16, v133
    v_and_b32 v167, s19, v133
    v_lshlrev_b32 v168, 16, v134
    v_and_b32 v169, s19, v134
    v_lshlrev_b32 v170, 16, v135
    v_and_b32 v171, s19, v135
    v_pk_mul_f32 v[164:165], v[164:165], s[18:19] op_sel_hi:[1,0]
    v_pk_mul_f32 v[166:167], v[166:167], s[18:19] op_sel_hi:[1,0]
    v_pk_mul_f32 v[168:169], v[168:169], s[18:19] op_sel_hi:[1,0]
    v_pk_mul_f32 v[170:171], v[170:171], s[18:19] op_sel_hi:[1,0]
    v_cvt_pk_bf16_f32 v132, v164, v165
    v_cvt_pk_bf16_f32 v133, v166, v167
    v_cvt_pk_bf16_f32 v134, v168, v169
    v_cvt_pk_bf16_f32 v135, v170, v171
    ds_write_b128 v161, v[132:135] offset:1024
    buffer_load_dwordx4 v109, s[28:31], s54 offen offset:1024  lds
    s_waitcnt vmcnt(11)
    v_lshlrev_b32 v164, 16, v136
    v_and_b32 v165, s19, v136
    v_lshlrev_b32 v166, 16, v137
    v_and_b32 v167, s19, v137
    v_lshlrev_b32 v168, 16, v138
    v_and_b32 v169, s19, v138
    v_lshlrev_b32 v170, 16, v139
    v_and_b32 v171, s19, v139
    v_pk_mul_f32 v[164:165], v[164:165], s[18:19] op_sel_hi:[1,0]
    v_pk_mul_f32 v[166:167], v[166:167], s[18:19] op_sel_hi:[1,0]
    v_pk_mul_f32 v[168:169], v[168:169], s[18:19] op_sel_hi:[1,0]
    v_pk_mul_f32 v[170:171], v[170:171], s[18:19] op_sel_hi:[1,0]
    v_cvt_pk_bf16_f32 v136, v164, v165
    v_cvt_pk_bf16_f32 v137, v166, v167
    v_cvt_pk_bf16_f32 v138, v168, v169
    v_cvt_pk_bf16_f32 v139, v170, v171
    ds_write_b128 v162, v[136:139] offset:2048
    buffer_load_dwordx4 v110, s[28:31], s54 offen offset:2048  lds
    s_waitcnt vmcnt(11)
    v_lshlrev_b32 v164, 16, v140
    v_and_b32 v165, s19, v140
    v_lshlrev_b32 v166, 16, v141
    v_and_b32 v167, s19, v141
    v_lshlrev_b32 v168, 16, v142
    v_and_b32 v169, s19, v142
    v_lshlrev_b32 v170, 16, v143
    v_and_b32 v171, s19, v143
    v_pk_mul_f32 v[164:165], v[164:165], s[18:19] op_sel_hi:[1,0]
    v_pk_mul_f32 v[166:167], v[166:167], s[18:19] op_sel_hi:[1,0]
    v_pk_mul_f32 v[168:169], v[168:169], s[18:19] op_sel_hi:[1,0]
    v_pk_mul_f32 v[170:171], v[170:171], s[18:19] op_sel_hi:[1,0]
    v_cvt_pk_bf16_f32 v140, v164, v165
    v_cvt_pk_bf16_f32 v141, v166, v167
    v_cvt_pk_bf16_f32 v142, v168, v169
    v_cvt_pk_bf16_f32 v143, v170, v171
    ds_write_b128 v163, v[140:143] offset:3072
    buffer_load_dwordx4 v111, s[28:31], s54 offen offset:3072  lds
    s_waitcnt lgkmcnt(0)
    s_barrier
    ds_read_b128 a[128:131], v144
    ds_read_b128 a[132:135], v145
    ds_read_b128 a[136:139], v146
    ds_read_b128 a[140:143], v147
    ds_read_b128 a[144:147], v148
    ds_read_b128 a[148:151], v149
    ds_read_b128 a[152:155], v150
    s_add_u32 m0, s42, 16384
    ds_read_b128 a[156:159], v151
    buffer_load_dwordx4 v112, s[32:35], s46 offen offset:0  lds
    buffer_load_dwordx4 v112, s[32:35], s46 offen offset:1024  lds
    buffer_load_dwordx4 v112, s[32:35], s46 offen offset:2048  lds
    buffer_load_dwordx4 v112, s[32:35], s46 offen offset:3072  lds
    s_waitcnt vmcnt(4)
    ds_read_b128 a[192:195], v96 offset:8192
    ds_read_b128 a[196:199], v97 offset:8192
    ds_read_b128 a[200:203], v98 offset:8192
    ds_read_b128 a[204:207], v99 offset:8192
    ds_read_b128 a[208:211], v100 offset:8192
    ds_read_b128 a[212:215], v101 offset:8192
    ds_read_b128 a[216:219], v102 offset:8192
    s_add_u32 m0, s42, 24576
    ds_read_b128 a[220:223], v103 offset:8192
    buffer_load_dwordx4 v108, s[28:31], s48 offen offset:0  lds
    buffer_load_dwordx4 v109, s[28:31], s48 offen offset:1024  lds
    ds_read_b128 a[160:163], v144 offset:40960
    s_waitcnt lgkmcnt(8)
    v_mfma_f32_32x32x16_bf16 v[16:31], a[192:195], a[128:131], 0
    buffer_load_dwordx4 v110, s[28:31], s48 offen offset:2048  lds
    ds_read_b128 a[164:167], v145 offset:40960
    s_waitcnt lgkmcnt(8)
    v_mfma_f32_32x32x16_bf16 v[16:31], a[196:199], a[132:135], v[16:31]
    buffer_load_dwordx4 v111, s[28:31], s48 offen offset:3072  lds
    ds_read_b128 a[168:171], v146 offset:40960
    s_waitcnt lgkmcnt(8)
    v_mfma_f32_32x32x16_bf16 v[16:31], a[200:203], a[136:139], v[16:31]
    ds_read_b128 a[172:175], v147 offset:40960
    s_waitcnt lgkmcnt(8)
    v_mfma_f32_32x32x16_bf16 v[16:31], a[204:207], a[140:143], v[16:31]
    ds_read_b128 a[176:179], v148 offset:40960
    s_waitcnt lgkmcnt(8)
    s_mov_b32 m0, s43
    v_mfma_f32_32x32x16_bf16 v[16:31], a[208:211], a[144:147], v[16:31]
    buffer_load_dwordx4 v108, s[28:31], s55 offen offset:0  lds
    ds_read_b128 a[180:183], v149 offset:40960
    s_waitcnt lgkmcnt(8)
    v_mfma_f32_32x32x16_bf16 v[16:31], a[212:215], a[148:151], v[16:31]
    buffer_load_dwordx4 v109, s[28:31], s55 offen offset:1024  lds
    ds_read_b128 a[184:187], v150 offset:40960
    s_waitcnt lgkmcnt(8)
    v_mfma_f32_32x32x16_bf16 v[16:31], a[216:219], a[152:155], v[16:31]
    buffer_load_dwordx4 v110, s[28:31], s55 offen offset:2048  lds
    ds_read_b128 a[188:191], v151 offset:40960
    s_waitcnt lgkmcnt(8)
    v_mfma_f32_32x32x16_bf16 v[16:31], a[220:223], a[156:159], v[16:31]
    buffer_load_dwordx4 v111, s[28:31], s55 offen offset:3072  lds
    s_waitcnt lgkmcnt(7)
    v_mfma_f32_32x32x16_bf16 v[32:47], a[192:195], a[160:163], 0
    s_waitcnt lgkmcnt(6)
    v_mfma_f32_32x32x16_bf16 v[32:47], a[196:199], a[164:167], v[32:47]
    s_waitcnt lgkmcnt(5)
    v_mfma_f32_32x32x16_bf16 v[32:47], a[200:203], a[168:171], v[32:47]
    v_max3_f32 v164, v16, v17, v118
    v_max3_f32 v165, v18, v19, v20
    v_max3_f32 v164, v21, v22, v164
    v_max3_f32 v165, v23, v24, v165
    v_max3_f32 v164, v25, v26, v164
    s_waitcnt lgkmcnt(4)
    v_mfma_f32_32x32x16_bf16 v[32:47], a[204:207], a[172:175], v[32:47]
    v_max3_f32 v165, v27, v28, v165
    v_max3_f32 v164, v29, v30, v164
    v_max3_f32 v164, v164, v165, v31
    v_mov_b32 v165, v164
    s_nop 1
    s_waitcnt lgkmcnt(3)
    v_mfma_f32_32x32x16_bf16 v[32:47], a[208:211], a[176:179], v[32:47]
    v_permlane32_swap_b32 v164, v165
    v_max_f32 v164, v164, v165
    v_sub_f32 v16, v16, v164
    v_sub_f32 v17, v17, v164
    v_sub_f32 v18, v18, v164
    s_waitcnt lgkmcnt(2)
    v_mfma_f32_32x32x16_bf16 v[32:47], a[212:215], a[180:183], v[32:47]
    v_sub_f32 v19, v19, v164
    v_sub_f32 v20, v20, v164
    v_sub_f32 v21, v21, v164
    v_sub_f32 v22, v22, v164
    v_sub_f32 v23, v23, v164
    s_waitcnt lgkmcnt(1)
    v_mfma_f32_32x32x16_bf16 v[32:47], a[216:219], a[184:187], v[32:47]
    v_sub_f32 v24, v24, v164
    v_sub_f32 v25, v25, v164
    v_sub_f32 v26, v26, v164
    v_sub_f32 v27, v27, v164
    v_sub_f32 v28, v28, v164
    s_waitcnt lgkmcnt(0)
    v_mfma_f32_32x32x16_bf16 v[32:47], a[220:223], a[188:191], v[32:47]
    v_sub_f32 v29, v29, v164
    v_sub_f32 v30, v30, v164
    v_sub_f32 v31, v31, v164
    s_barrier
    v_exp_f32 v16, v16
    v_sub_f32 v48, 0, v164
    v_exp_f32 v17, v17
    v_add_f32 v113, v113, v16
    v_sub_f32 v49, 0, v164
    v_exp_f32 v18, v18
    v_add_f32 v113, v113, v17
    v_cvt_pk_bf16_f32 v80, v16, v17
    v_sub_f32 v50, 0, v164
    v_exp_f32 v19, v19
    v_add_f32 v113, v113, v18
    v_sub_f32 v51, 0, v164
    v_exp_f32 v20, v20
    v_add_f32 v113, v113, v19
    v_cvt_pk_bf16_f32 v81, v18, v19
    v_sub_f32 v52, 0, v164
    v_exp_f32 v21, v21
    v_add_f32 v113, v113, v20
    s_add_u32 m0, s43, 16384
    v_sub_f32 v53, 0, v164
    buffer_load_dwordx4 v112, s[32:35], s54 offen offset:0  lds
    v_exp_f32 v22, v22
    v_add_f32 v113, v113, v21
    v_cvt_pk_bf16_f32 v82, v20, v21
    v_sub_f32 v54, 0, v164
    v_exp_f32 v23, v23
    v_add_f32 v113, v113, v22
    v_sub_f32 v55, 0, v164
    buffer_load_dwordx4 v112, s[32:35], s54 offen offset:1024  lds
    v_exp_f32 v24, v24
    v_add_f32 v113, v113, v23
    v_cvt_pk_bf16_f32 v83, v22, v23
    v_sub_f32 v56, 0, v164
    v_exp_f32 v25, v25
    v_add_f32 v113, v113, v24
    v_sub_f32 v57, 0, v164
    buffer_load_dwordx4 v112, s[32:35], s54 offen offset:2048  lds
    v_exp_f32 v26, v26
    v_add_f32 v113, v113, v25
    v_cvt_pk_bf16_f32 v84, v24, v25
    v_sub_f32 v58, 0, v164
    v_exp_f32 v27, v27
    v_add_f32 v113, v113, v26
    v_sub_f32 v59, 0, v164
    buffer_load_dwordx4 v112, s[32:35], s54 offen offset:3072  lds
    v_exp_f32 v28, v28
    v_add_f32 v113, v113, v27
    v_cvt_pk_bf16_f32 v85, v26, v27
    v_sub_f32 v60, 0, v164
    v_exp_f32 v29, v29
    v_add_f32 v113, v113, v28
    s_add_u32 m0, s43, 24576
    v_sub_f32 v61, 0, v164
    buffer_load_dwordx4 v108, s[28:31], s56 offen offset:0  lds
    v_exp_f32 v30, v30
    v_add_f32 v113, v113, v29
    v_cvt_pk_bf16_f32 v86, v28, v29
    v_sub_f32 v62, 0, v164
    v_exp_f32 v31, v31
    v_add_f32 v113, v113, v30
    v_sub_f32 v63, 0, v164
    buffer_load_dwordx4 v109, s[28:31], s56 offen offset:1024  lds
    v_add_f32 v113, v113, v31
    v_cvt_pk_bf16_f32 v87, v30, v31
    v_max3_f32 v166, v32, v33, v119
    v_max3_f32 v167, v34, v35, v36
    v_max3_f32 v166, v37, v38, v166
    v_max3_f32 v167, v39, v40, v167
    buffer_load_dwordx4 v110, s[28:31], s56 offen offset:2048  lds
    v_max3_f32 v166, v41, v42, v166
    v_max3_f32 v167, v43, v44, v167
    v_max3_f32 v166, v45, v46, v166
    v_max3_f32 v166, v166, v167, v47
    buffer_load_dwordx4 v111, s[28:31], s56 offen offset:3072  lds
    v_mov_b32 v167, v166
    s_nop 1
    v_permlane32_swap_b32 v166, v167
    s_add_u32 m0, s42, 8192
    v_max_f32 v166, v166, v167
    buffer_load_dwordx4 v112, s[32:35], s47 offen offset:0  lds
    v_sub_f32 v32, v32, v166
    v_sub_f32 v33, v33, v166
    v_sub_f32 v34, v34, v166
    v_sub_f32 v35, v35, v166
    buffer_load_dwordx4 v112, s[32:35], s47 offen offset:1024  lds
    v_sub_f32 v36, v36, v166
    v_sub_f32 v37, v37, v166
    v_sub_f32 v38, v38, v166
    v_sub_f32 v39, v39, v166
    buffer_load_dwordx4 v112, s[32:35], s47 offen offset:2048  lds
    v_sub_f32 v40, v40, v166
    v_sub_f32 v41, v41, v166
    v_sub_f32 v42, v42, v166
    v_sub_f32 v43, v43, v166
    buffer_load_dwordx4 v112, s[32:35], s47 offen offset:3072  lds
    v_sub_f32 v44, v44, v166
    v_sub_f32 v45, v45, v166
    v_sub_f32 v46, v46, v166
    v_sub_f32 v47, v47, v166
    s_waitcnt vmcnt(12)
    ds_read_b128 a[192:195], v96 offset:0
    ds_read_b128 a[196:199], v97 offset:0
    ds_read_b128 a[200:203], v98 offset:0
    ds_read_b128 a[204:207], v99 offset:0
    ds_read_b128 a[208:211], v100 offset:0
    ds_read_b128 a[212:215], v101 offset:0
    ds_read_b128 a[216:219], v102 offset:0
    ds_read_b128 a[220:223], v103 offset:0
    v_sub_f32 v64, 0, v166
    v_sub_f32 v65, 0, v166
    v_sub_f32 v66, 0, v166
    v_sub_f32 v67, 0, v166
    v_sub_f32 v68, 0, v166
    v_sub_f32 v69, 0, v166
    v_sub_f32 v70, 0, v166
    s_add_u32 m0, s42, 32768
    v_sub_f32 v71, 0, v166
    buffer_load_dwordx4 v108, s[28:31], s49 offen offset:0  lds
    v_sub_f32 v72, 0, v166
    v_sub_f32 v73, 0, v166
    v_sub_f32 v74, 0, v166
    v_sub_f32 v75, 0, v166
    buffer_load_dwordx4 v109, s[28:31], s49 offen offset:1024  lds
    v_sub_f32 v76, 0, v166
    v_sub_f32 v77, 0, v166
    v_sub_f32 v78, 0, v166
    v_sub_f32 v79, 0, v166
    buffer_load_dwordx4 v110, s[28:31], s49 offen offset:2048  lds
    s_waitcnt lgkmcnt(0)
    v_mfma_f32_32x32x16_bf16 v[16:31], a[192:195], a[128:131], v[48:63]
    v_exp_f32 v32, v32
    s_waitcnt vmcnt(11)
    ds_read_b64_tr_b16 a[224:225], v104 offset:16384
    ds_read_b64_tr_b16 a[226:227], v104 offset:18432
    buffer_load_dwordx4 v111, s[28:31], s49 offen offset:3072  lds
    s_add_u32 m0, s43, 8192
    v_mfma_f32_32x32x16_bf16 v[16:31], a[196:199], a[132:135], v[16:31]
    buffer_load_dwordx4 v112, s[32:35], s55 offen offset:0  lds
    v_exp_f32 v33, v33
    v_add_f32 v114, v114, v32
    ds_read_b64_tr_b16 a[232:233], v105 offset:16384
    ds_read_b64_tr_b16 a[234:235], v105 offset:18432
    v_mfma_f32_32x32x16_bf16 v[16:31], a[200:203], a[136:139], v[16:31]
    v_exp_f32 v34, v34
    v_add_f32 v114, v114, v33
    v_cvt_pk_bf16_f32 v88, v32, v33
    ds_read_b64_tr_b16 a[240:241], v106 offset:16384
    ds_read_b64_tr_b16 a[242:243], v106 offset:18432
    v_mfma_f32_32x32x16_bf16 v[16:31], a[204:207], a[140:143], v[16:31]
    buffer_load_dwordx4 v112, s[32:35], s55 offen offset:1024  lds
    v_exp_f32 v35, v35
    v_add_f32 v114, v114, v34
    ds_read_b64_tr_b16 a[248:249], v107 offset:16384
    ds_read_b64_tr_b16 a[250:251], v107 offset:18432
    v_mfma_f32_32x32x16_bf16 v[16:31], a[208:211], a[144:147], v[16:31]
    v_exp_f32 v36, v36
    v_add_f32 v114, v114, v35
    v_cvt_pk_bf16_f32 v89, v34, v35
    ds_read_b64_tr_b16 a[228:229], v104 offset:20480
    ds_read_b64_tr_b16 a[230:231], v104 offset:22528
    v_mfma_f32_32x32x16_bf16 v[16:31], a[212:215], a[148:151], v[16:31]
    buffer_load_dwordx4 v112, s[32:35], s55 offen offset:2048  lds
    v_exp_f32 v37, v37
    v_add_f32 v114, v114, v36
    ds_read_b64_tr_b16 a[236:237], v105 offset:20480
    ds_read_b64_tr_b16 a[238:239], v105 offset:22528
    v_mfma_f32_32x32x16_bf16 v[16:31], a[216:219], a[152:155], v[16:31]
    v_exp_f32 v38, v38
    v_add_f32 v114, v114, v37
    v_cvt_pk_bf16_f32 v90, v36, v37
    ds_read_b64_tr_b16 a[244:245], v106 offset:20480
    ds_read_b64_tr_b16 a[246:247], v106 offset:22528
    v_mfma_f32_32x32x16_bf16 v[16:31], a[220:223], a[156:159], v[16:31]
    buffer_load_dwordx4 v112, s[32:35], s55 offen offset:3072  lds
    v_exp_f32 v39, v39
    v_add_f32 v114, v114, v38
    ds_read_b64_tr_b16 a[252:253], v107 offset:20480
    ds_read_b64_tr_b16 a[254:255], v107 offset:22528
    s_waitcnt lgkmcnt(8)
    v_mfma_f32_32x32x16_bf16 v[224:239], a[224:227], v[80:83], 0
    v_exp_f32 v40, v40
    v_add_f32 v114, v114, v39
    v_cvt_pk_bf16_f32 v91, v38, v39
    s_mov_b32 m0, s42
    v_mfma_f32_32x32x16_bf16 a[16:31], a[232:235], v[80:83], 0
    buffer_load_dwordx4 v108, s[28:31], s50 offen offset:0  lds
    v_exp_f32 v41, v41
    v_add_f32 v114, v114, v40
    v_mfma_f32_32x32x16_bf16 a[32:47], a[240:243], v[80:83], 0
    v_exp_f32 v42, v42
    v_add_f32 v114, v114, v41
    v_cvt_pk_bf16_f32 v92, v40, v41
    v_mfma_f32_32x32x16_bf16 a[48:63], a[248:251], v[80:83], 0
    buffer_load_dwordx4 v109, s[28:31], s50 offen offset:1024  lds
    v_exp_f32 v43, v43
    v_add_f32 v114, v114, v42
    s_waitcnt lgkmcnt(0)
    v_mfma_f32_32x32x16_bf16 v[224:239], a[228:231], v[84:87], v[224:239]
    v_exp_f32 v44, v44
    v_add_f32 v114, v114, v43
    v_cvt_pk_bf16_f32 v93, v42, v43
    v_mfma_f32_32x32x16_bf16 a[16:31], a[236:239], v[84:87], a[16:31]
    buffer_load_dwordx4 v110, s[28:31], s50 offen offset:2048  lds
    v_exp_f32 v45, v45
    v_add_f32 v114, v114, v44
    v_mfma_f32_32x32x16_bf16 a[32:47], a[244:247], v[84:87], a[32:47]
    v_exp_f32 v46, v46
    v_add_f32 v114, v114, v45
    v_cvt_pk_bf16_f32 v94, v44, v45
    v_mfma_f32_32x32x16_bf16 a[48:63], a[252:255], v[84:87], a[48:63]
    buffer_load_dwordx4 v111, s[28:31], s50 offen offset:3072  lds
    v_exp_f32 v47, v47
    v_add_f32 v114, v114, v46
    v_add_f32 v114, v114, v47
    v_cvt_pk_bf16_f32 v95, v46, v47
    v_mfma_f32_32x32x16_bf16 v[32:47], a[192:195], a[160:163], v[64:79]
    v_exp_f32 v16, v16
    s_add_u32 m0, s42, 16384
    v_mfma_f32_32x32x16_bf16 v[32:47], a[196:199], a[164:167], v[32:47]
    buffer_load_dwordx4 v112, s[32:35], s48 offen offset:0  lds
    v_exp_f32 v17, v17
    v_add_f32 v113, v113, v16
    v_mfma_f32_32x32x16_bf16 v[32:47], a[200:203], a[168:171], v[32:47]
    v_exp_f32 v18, v18
    v_add_f32 v113, v113, v17
    v_cvt_pk_bf16_f32 v80, v16, v17
    v_mfma_f32_32x32x16_bf16 v[32:47], a[204:207], a[172:175], v[32:47]
    buffer_load_dwordx4 v112, s[32:35], s48 offen offset:1024  lds
    v_exp_f32 v19, v19
    v_add_f32 v113, v113, v18
    v_mfma_f32_32x32x16_bf16 v[32:47], a[208:211], a[176:179], v[32:47]
    v_exp_f32 v20, v20
    v_add_f32 v113, v113, v19
    v_cvt_pk_bf16_f32 v81, v18, v19
    v_mfma_f32_32x32x16_bf16 v[32:47], a[212:215], a[180:183], v[32:47]
    buffer_load_dwordx4 v112, s[32:35], s48 offen offset:2048  lds
    v_exp_f32 v21, v21
    v_add_f32 v113, v113, v20
    v_mfma_f32_32x32x16_bf16 v[32:47], a[216:219], a[184:187], v[32:47]
    v_exp_f32 v22, v22
    v_add_f32 v113, v113, v21
    v_cvt_pk_bf16_f32 v82, v20, v21
    v_mfma_f32_32x32x16_bf16 v[32:47], a[220:223], a[188:191], v[32:47]
    buffer_load_dwordx4 v112, s[32:35], s48 offen offset:3072  lds
    v_exp_f32 v23, v23
    v_add_f32 v113, v113, v22
    s_waitcnt vmcnt(20)
    v_mfma_f32_32x32x16_bf16 v[240:255], a[224:227], v[88:91], 0
    v_exp_f32 v24, v24
    v_add_f32 v113, v113, v23
    v_cvt_pk_bf16_f32 v83, v22, v23
    ds_read_b128 a[192:195], v96 offset:24576
    ds_read_b128 a[196:199], v97 offset:24576
    s_add_u32 m0, s43, 32768
    v_mfma_f32_32x32x16_bf16 a[80:95], a[232:235], v[88:91], 0
    buffer_load_dwordx4 v108, s[28:31], s57 offen offset:0  lds
    v_exp_f32 v25, v25
    v_add_f32 v113, v113, v24
    ds_read_b128 a[200:203], v98 offset:24576
    ds_read_b128 a[204:207], v99 offset:24576
    v_mfma_f32_32x32x16_bf16 a[96:111], a[240:243], v[88:91], 0
    v_exp_f32 v26, v26
    v_add_f32 v113, v113, v25
    v_cvt_pk_bf16_f32 v84, v24, v25
    ds_read_b128 a[208:211], v100 offset:24576
    ds_read_b128 a[212:215], v101 offset:24576
    v_mfma_f32_32x32x16_bf16 a[112:127], a[248:251], v[88:91], 0
    buffer_load_dwordx4 v109, s[28:31], s57 offen offset:1024  lds
    v_exp_f32 v27, v27
    v_add_f32 v113, v113, v26
    ds_read_b128 a[216:219], v102 offset:24576
    ds_read_b128 a[220:223], v103 offset:24576
    v_mfma_f32_32x32x16_bf16 v[240:255], a[228:231], v[92:95], v[240:255]
    v_exp_f32 v28, v28
    v_add_f32 v113, v113, v27
    v_cvt_pk_bf16_f32 v85, v26, v27
    v_mfma_f32_32x32x16_bf16 a[80:95], a[236:239], v[92:95], a[80:95]
    buffer_load_dwordx4 v110, s[28:31], s57 offen offset:2048  lds
    v_exp_f32 v29, v29
    v_add_f32 v113, v113, v28
    v_mfma_f32_32x32x16_bf16 a[96:111], a[244:247], v[92:95], a[96:111]
    v_exp_f32 v30, v30
    v_add_f32 v113, v113, v29
    v_cvt_pk_bf16_f32 v86, v28, v29
    v_mfma_f32_32x32x16_bf16 a[112:127], a[252:255], v[92:95], a[112:127]
    buffer_load_dwordx4 v111, s[28:31], s57 offen offset:3072  lds
    v_exp_f32 v31, v31
    v_add_f32 v113, v113, v30
    s_nop 0
    v_add_f32 v113, v113, v31
    v_cvt_pk_bf16_f32 v87, v30, v31
    s_waitcnt lgkmcnt(0)
    v_mfma_f32_32x32x16_bf16 v[16:31], a[192:195], a[128:131], v[48:63]
    v_exp_f32 v32, v32
    s_waitcnt vmcnt(12)
    ds_read_b64_tr_b16 a[224:225], v104 offset:8192
    ds_read_b64_tr_b16 a[226:227], v104 offset:10240
    s_add_u32 m0, s43, 16384
    v_mfma_f32_32x32x16_bf16 v[16:31], a[196:199], a[132:135], v[16:31]
    buffer_load_dwordx4 v112, s[32:35], s56 offen offset:0  lds
    v_exp_f32 v33, v33
    v_add_f32 v114, v114, v32
    ds_read_b64_tr_b16 a[232:233], v105 offset:8192
    ds_read_b64_tr_b16 a[234:235], v105 offset:10240
    v_mfma_f32_32x32x16_bf16 v[16:31], a[200:203], a[136:139], v[16:31]
    v_exp_f32 v34, v34
    v_add_f32 v114, v114, v33
    v_cvt_pk_bf16_f32 v88, v32, v33
    ds_read_b64_tr_b16 a[240:241], v106 offset:8192
    ds_read_b64_tr_b16 a[242:243], v106 offset:10240
    v_mfma_f32_32x32x16_bf16 v[16:31], a[204:207], a[140:143], v[16:31]
    buffer_load_dwordx4 v112, s[32:35], s56 offen offset:1024  lds
    v_exp_f32 v35, v35
    v_add_f32 v114, v114, v34
    ds_read_b64_tr_b16 a[248:249], v107 offset:8192
    ds_read_b64_tr_b16 a[250:251], v107 offset:10240
    v_mfma_f32_32x32x16_bf16 v[16:31], a[208:211], a[144:147], v[16:31]
    v_exp_f32 v36, v36
    v_add_f32 v114, v114, v35
    v_cvt_pk_bf16_f32 v89, v34, v35
    ds_read_b64_tr_b16 a[228:229], v104 offset:12288
    ds_read_b64_tr_b16 a[230:231], v104 offset:14336
    v_mfma_f32_32x32x16_bf16 v[16:31], a[212:215], a[148:151], v[16:31]
    buffer_load_dwordx4 v112, s[32:35], s56 offen offset:2048  lds
    v_exp_f32 v37, v37
    v_add_f32 v114, v114, v36
    ds_read_b64_tr_b16 a[236:237], v105 offset:12288
    ds_read_b64_tr_b16 a[238:239], v105 offset:14336
    v_mfma_f32_32x32x16_bf16 v[16:31], a[216:219], a[152:155], v[16:31]
    v_exp_f32 v38, v38
    v_add_f32 v114, v114, v37
    v_cvt_pk_bf16_f32 v90, v36, v37
    ds_read_b64_tr_b16 a[244:245], v106 offset:12288
    ds_read_b64_tr_b16 a[246:247], v106 offset:14336
    v_mfma_f32_32x32x16_bf16 v[16:31], a[220:223], a[156:159], v[16:31]
    buffer_load_dwordx4 v112, s[32:35], s56 offen offset:3072  lds
    v_exp_f32 v39, v39
    v_add_f32 v114, v114, v38
    ds_read_b64_tr_b16 a[252:253], v107 offset:12288
    ds_read_b64_tr_b16 a[254:255], v107 offset:14336
    s_waitcnt lgkmcnt(8)
    v_mfma_f32_32x32x16_bf16 v[224:239], a[224:227], v[80:83], v[224:239]
    v_exp_f32 v40, v40
    v_add_f32 v114, v114, v39
    v_cvt_pk_bf16_f32 v91, v38, v39
    s_mov_b32 m0, s43
    v_mfma_f32_32x32x16_bf16 a[16:31], a[232:235], v[80:83], a[16:31]
    buffer_load_dwordx4 v108, s[28:31], s58 offen offset:0  lds
    v_exp_f32 v41, v41
    v_add_f32 v114, v114, v40
    v_mfma_f32_32x32x16_bf16 a[32:47], a[240:243], v[80:83], a[32:47]
    v_exp_f32 v42, v42
    v_add_f32 v114, v114, v41
    v_cvt_pk_bf16_f32 v92, v40, v41
    v_mfma_f32_32x32x16_bf16 a[48:63], a[248:251], v[80:83], a[48:63]
    buffer_load_dwordx4 v109, s[28:31], s58 offen offset:1024  lds
    v_exp_f32 v43, v43
    v_add_f32 v114, v114, v42
    s_waitcnt lgkmcnt(0)
    v_mfma_f32_32x32x16_bf16 v[224:239], a[228:231], v[84:87], v[224:239]
    v_exp_f32 v44, v44
    v_add_f32 v114, v114, v43
    v_cvt_pk_bf16_f32 v93, v42, v43
    v_mfma_f32_32x32x16_bf16 a[16:31], a[236:239], v[84:87], a[16:31]
    buffer_load_dwordx4 v110, s[28:31], s58 offen offset:2048  lds
    v_exp_f32 v45, v45
    v_add_f32 v114, v114, v44
    v_mfma_f32_32x32x16_bf16 a[32:47], a[244:247], v[84:87], a[32:47]
    v_exp_f32 v46, v46
    v_add_f32 v114, v114, v45
    v_cvt_pk_bf16_f32 v94, v44, v45
    v_mfma_f32_32x32x16_bf16 a[48:63], a[252:255], v[84:87], a[48:63]
    buffer_load_dwordx4 v111, s[28:31], s58 offen offset:3072  lds
    v_exp_f32 v47, v47
    v_add_f32 v114, v114, v46
    v_add_f32 v114, v114, v47
    v_cvt_pk_bf16_f32 v95, v46, v47
    v_mfma_f32_32x32x16_bf16 v[32:47], a[192:195], a[160:163], v[64:79]
    v_exp_f32 v16, v16
    s_add_u32 m0, s42, 24576
    v_mfma_f32_32x32x16_bf16 v[32:47], a[196:199], a[164:167], v[32:47]
    buffer_load_dwordx4 v112, s[32:35], s49 offen offset:0  lds
    v_exp_f32 v17, v17
    v_add_f32 v113, v113, v16
    v_mfma_f32_32x32x16_bf16 v[32:47], a[200:203], a[168:171], v[32:47]
    v_exp_f32 v18, v18
    v_add_f32 v113, v113, v17
    v_cvt_pk_bf16_f32 v80, v16, v17
    v_mfma_f32_32x32x16_bf16 v[32:47], a[204:207], a[172:175], v[32:47]
    buffer_load_dwordx4 v112, s[32:35], s49 offen offset:1024  lds
    v_exp_f32 v19, v19
    v_add_f32 v113, v113, v18
    v_mfma_f32_32x32x16_bf16 v[32:47], a[208:211], a[176:179], v[32:47]
    v_exp_f32 v20, v20
    v_add_f32 v113, v113, v19
    v_cvt_pk_bf16_f32 v81, v18, v19
    v_mfma_f32_32x32x16_bf16 v[32:47], a[212:215], a[180:183], v[32:47]
    buffer_load_dwordx4 v112, s[32:35], s49 offen offset:2048  lds
    v_exp_f32 v21, v21
    v_add_f32 v113, v113, v20
    v_mfma_f32_32x32x16_bf16 v[32:47], a[216:219], a[184:187], v[32:47]
    v_exp_f32 v22, v22
    v_add_f32 v113, v113, v21
    v_cvt_pk_bf16_f32 v82, v20, v21
    v_mfma_f32_32x32x16_bf16 v[32:47], a[220:223], a[188:191], v[32:47]
    buffer_load_dwordx4 v112, s[32:35], s49 offen offset:3072  lds
    v_exp_f32 v23, v23
    v_add_f32 v113, v113, v22
    s_waitcnt vmcnt(12)
    v_mfma_f32_32x32x16_bf16 v[240:255], a[224:227], v[88:91], v[240:255]
    v_exp_f32 v24, v24
    v_add_f32 v113, v113, v23
    v_cvt_pk_bf16_f32 v83, v22, v23
    ds_read_b128 a[192:195], v96 offset:32768
    ds_read_b128 a[196:199], v97 offset:32768
    s_add_u32 m0, s42, 8192
    v_mfma_f32_32x32x16_bf16 a[80:95], a[232:235], v[88:91], a[80:95]
    buffer_load_dwordx4 v108, s[28:31], s51 offen offset:0  lds
    v_exp_f32 v25, v25
    v_add_f32 v113, v113, v24
    ds_read_b128 a[200:203], v98 offset:32768
    ds_read_b128 a[204:207], v99 offset:32768
    v_mfma_f32_32x32x16_bf16 a[96:111], a[240:243], v[88:91], a[96:111]
    v_exp_f32 v26, v26
    v_add_f32 v113, v113, v25
    v_cvt_pk_bf16_f32 v84, v24, v25
    ds_read_b128 a[208:211], v100 offset:32768
    ds_read_b128 a[212:215], v101 offset:32768
    v_mfma_f32_32x32x16_bf16 a[112:127], a[248:251], v[88:91], a[112:127]
    buffer_load_dwordx4 v109, s[28:31], s51 offen offset:1024  lds
    v_exp_f32 v27, v27
    v_add_f32 v113, v113, v26
    ds_read_b128 a[216:219], v102 offset:32768
    ds_read_b128 a[220:223], v103 offset:32768
    v_mfma_f32_32x32x16_bf16 v[240:255], a[228:231], v[92:95], v[240:255]
    v_exp_f32 v28, v28
    v_add_f32 v113, v113, v27
    v_cvt_pk_bf16_f32 v85, v26, v27
    v_mfma_f32_32x32x16_bf16 a[80:95], a[236:239], v[92:95], a[80:95]
    buffer_load_dwordx4 v110, s[28:31], s51 offen offset:2048  lds
    v_exp_f32 v29, v29
    v_add_f32 v113, v113, v28
    v_mfma_f32_32x32x16_bf16 a[96:111], a[244:247], v[92:95], a[96:111]
    v_exp_f32 v30, v30
    v_add_f32 v113, v113, v29
    v_cvt_pk_bf16_f32 v86, v28, v29
    v_mfma_f32_32x32x16_bf16 a[112:127], a[252:255], v[92:95], a[112:127]
    buffer_load_dwordx4 v111, s[28:31], s51 offen offset:3072  lds
    v_exp_f32 v31, v31
    v_add_f32 v113, v113, v30
    s_nop 0
    v_add_f32 v113, v113, v31
    v_cvt_pk_bf16_f32 v87, v30, v31
    s_waitcnt lgkmcnt(0)
    v_mfma_f32_32x32x16_bf16 v[16:31], a[192:195], a[128:131], v[48:63]
    v_exp_f32 v32, v32
    s_waitcnt vmcnt(12)
    ds_read_b64_tr_b16 a[224:225], v104 offset:16384
    ds_read_b64_tr_b16 a[226:227], v104 offset:18432
    s_add_u32 m0, s43, 24576
    v_mfma_f32_32x32x16_bf16 v[16:31], a[196:199], a[132:135], v[16:31]
    buffer_load_dwordx4 v112, s[32:35], s57 offen offset:0  lds
    v_exp_f32 v33, v33
    v_add_f32 v114, v114, v32
    ds_read_b64_tr_b16 a[232:233], v105 offset:16384
    ds_read_b64_tr_b16 a[234:235], v105 offset:18432
    v_mfma_f32_32x32x16_bf16 v[16:31], a[200:203], a[136:139], v[16:31]
    v_exp_f32 v34, v34
    v_add_f32 v114, v114, v33
    v_cvt_pk_bf16_f32 v88, v32, v33
    ds_read_b64_tr_b16 a[240:241], v106 offset:16384
    ds_read_b64_tr_b16 a[242:243], v106 offset:18432
    v_mfma_f32_32x32x16_bf16 v[16:31], a[204:207], a[140:143], v[16:31]
    buffer_load_dwordx4 v112, s[32:35], s57 offen offset:1024  lds
    v_exp_f32 v35, v35
    v_add_f32 v114, v114, v34
    ds_read_b64_tr_b16 a[248:249], v107 offset:16384
    ds_read_b64_tr_b16 a[250:251], v107 offset:18432
    v_mfma_f32_32x32x16_bf16 v[16:31], a[208:211], a[144:147], v[16:31]
    v_exp_f32 v36, v36
    v_add_f32 v114, v114, v35
    v_cvt_pk_bf16_f32 v89, v34, v35
    ds_read_b64_tr_b16 a[228:229], v104 offset:20480
    ds_read_b64_tr_b16 a[230:231], v104 offset:22528
    v_mfma_f32_32x32x16_bf16 v[16:31], a[212:215], a[148:151], v[16:31]
    buffer_load_dwordx4 v112, s[32:35], s57 offen offset:2048  lds
    v_exp_f32 v37, v37
    v_add_f32 v114, v114, v36
    ds_read_b64_tr_b16 a[236:237], v105 offset:20480
    ds_read_b64_tr_b16 a[238:239], v105 offset:22528
    v_mfma_f32_32x32x16_bf16 v[16:31], a[216:219], a[152:155], v[16:31]
    v_exp_f32 v38, v38
    v_add_f32 v114, v114, v37
    v_cvt_pk_bf16_f32 v90, v36, v37
    ds_read_b64_tr_b16 a[244:245], v106 offset:20480
    ds_read_b64_tr_b16 a[246:247], v106 offset:22528
    v_mfma_f32_32x32x16_bf16 v[16:31], a[220:223], a[156:159], v[16:31]
    buffer_load_dwordx4 v112, s[32:35], s57 offen offset:3072  lds
    v_exp_f32 v39, v39
    v_add_f32 v114, v114, v38
    ds_read_b64_tr_b16 a[252:253], v107 offset:20480
    ds_read_b64_tr_b16 a[254:255], v107 offset:22528
    s_waitcnt lgkmcnt(8)
    v_mfma_f32_32x32x16_bf16 v[224:239], a[224:227], v[80:83], v[224:239]
    v_exp_f32 v40, v40
    v_add_f32 v114, v114, v39
    v_cvt_pk_bf16_f32 v91, v38, v39
    s_add_u32 m0, s42, 32768
    v_mfma_f32_32x32x16_bf16 a[16:31], a[232:235], v[80:83], a[16:31]
    buffer_load_dwordx4 v108, s[28:31], s52 offen offset:0  lds
    v_exp_f32 v41, v41
    v_add_f32 v114, v114, v40
    v_mfma_f32_32x32x16_bf16 a[32:47], a[240:243], v[80:83], a[32:47]
    v_exp_f32 v42, v42
    v_add_f32 v114, v114, v41
    v_cvt_pk_bf16_f32 v92, v40, v41
    v_mfma_f32_32x32x16_bf16 a[48:63], a[248:251], v[80:83], a[48:63]
    buffer_load_dwordx4 v109, s[28:31], s52 offen offset:1024  lds
    v_exp_f32 v43, v43
    v_add_f32 v114, v114, v42
    s_waitcnt lgkmcnt(0)
    v_mfma_f32_32x32x16_bf16 v[224:239], a[228:231], v[84:87], v[224:239]
    v_exp_f32 v44, v44
    v_add_f32 v114, v114, v43
    v_cvt_pk_bf16_f32 v93, v42, v43
    v_mfma_f32_32x32x16_bf16 a[16:31], a[236:239], v[84:87], a[16:31]
    buffer_load_dwordx4 v110, s[28:31], s52 offen offset:2048  lds
    v_exp_f32 v45, v45
    v_add_f32 v114, v114, v44
    v_mfma_f32_32x32x16_bf16 a[32:47], a[244:247], v[84:87], a[32:47]
    v_exp_f32 v46, v46
    v_add_f32 v114, v114, v45
    v_cvt_pk_bf16_f32 v94, v44, v45
    v_mfma_f32_32x32x16_bf16 a[48:63], a[252:255], v[84:87], a[48:63]
    buffer_load_dwordx4 v111, s[28:31], s52 offen offset:3072  lds
    v_exp_f32 v47, v47
    v_add_f32 v114, v114, v46
    v_add_f32 v114, v114, v47
    v_cvt_pk_bf16_f32 v95, v46, v47
    v_mfma_f32_32x32x16_bf16 v[32:47], a[192:195], a[160:163], v[64:79]
    v_exp_f32 v16, v16
    s_add_u32 m0, s42, 16384
    v_mfma_f32_32x32x16_bf16 v[32:47], a[196:199], a[164:167], v[32:47]
    buffer_load_dwordx4 v112, s[32:35], s50 offen offset:0  lds
    v_exp_f32 v17, v17
    v_add_f32 v113, v113, v16
    v_mfma_f32_32x32x16_bf16 v[32:47], a[200:203], a[168:171], v[32:47]
    v_exp_f32 v18, v18
    v_add_f32 v113, v113, v17
    v_cvt_pk_bf16_f32 v80, v16, v17
    v_mfma_f32_32x32x16_bf16 v[32:47], a[204:207], a[172:175], v[32:47]
    buffer_load_dwordx4 v112, s[32:35], s50 offen offset:1024  lds
    v_exp_f32 v19, v19
    v_add_f32 v113, v113, v18
    v_mfma_f32_32x32x16_bf16 v[32:47], a[208:211], a[176:179], v[32:47]
    v_exp_f32 v20, v20
    v_add_f32 v113, v113, v19
    v_cvt_pk_bf16_f32 v81, v18, v19
    v_mfma_f32_32x32x16_bf16 v[32:47], a[212:215], a[180:183], v[32:47]
    buffer_load_dwordx4 v112, s[32:35], s50 offen offset:2048  lds
    v_exp_f32 v21, v21
    v_add_f32 v113, v113, v20
    v_mfma_f32_32x32x16_bf16 v[32:47], a[216:219], a[184:187], v[32:47]
    v_exp_f32 v22, v22
    v_add_f32 v113, v113, v21
    v_cvt_pk_bf16_f32 v82, v20, v21
    v_mfma_f32_32x32x16_bf16 v[32:47], a[220:223], a[188:191], v[32:47]
    buffer_load_dwordx4 v112, s[32:35], s50 offen offset:3072  lds
    v_exp_f32 v23, v23
    v_add_f32 v113, v113, v22
    s_waitcnt vmcnt(20)
    v_mfma_f32_32x32x16_bf16 v[240:255], a[224:227], v[88:91], v[240:255]
    v_exp_f32 v24, v24
    v_add_f32 v113, v113, v23
    v_cvt_pk_bf16_f32 v83, v22, v23
    ds_read_b128 a[192:195], v96 offset:0
    ds_read_b128 a[196:199], v97 offset:0
    s_add_u32 m0, s43, 8192
    v_mfma_f32_32x32x16_bf16 a[80:95], a[232:235], v[88:91], a[80:95]
    buffer_load_dwordx4 v108, s[28:31], s59 offen offset:0  lds
    v_exp_f32 v25, v25
    v_add_f32 v113, v113, v24
    ds_read_b128 a[200:203], v98 offset:0
    ds_read_b128 a[204:207], v99 offset:0
    v_mfma_f32_32x32x16_bf16 a[96:111], a[240:243], v[88:91], a[96:111]
    v_exp_f32 v26, v26
    v_add_f32 v113, v113, v25
    v_cvt_pk_bf16_f32 v84, v24, v25
    ds_read_b128 a[208:211], v100 offset:0
    ds_read_b128 a[212:215], v101 offset:0
    v_mfma_f32_32x32x16_bf16 a[112:127], a[248:251], v[88:91], a[112:127]
    buffer_load_dwordx4 v109, s[28:31], s59 offen offset:1024  lds
    v_exp_f32 v27, v27
    v_add_f32 v113, v113, v26
    ds_read_b128 a[216:219], v102 offset:0
    ds_read_b128 a[220:223], v103 offset:0
    v_mfma_f32_32x32x16_bf16 v[240:255], a[228:231], v[92:95], v[240:255]
    v_exp_f32 v28, v28
    v_add_f32 v113, v113, v27
    v_cvt_pk_bf16_f32 v85, v26, v27
    v_mfma_f32_32x32x16_bf16 a[80:95], a[236:239], v[92:95], a[80:95]
    buffer_load_dwordx4 v110, s[28:31], s59 offen offset:2048  lds
    v_exp_f32 v29, v29
    v_add_f32 v113, v113, v28
    v_mfma_f32_32x32x16_bf16 a[96:111], a[244:247], v[92:95], a[96:111]
    v_exp_f32 v30, v30
    v_add_f32 v113, v113, v29
    v_cvt_pk_bf16_f32 v86, v28, v29
    v_mfma_f32_32x32x16_bf16 a[112:127], a[252:255], v[92:95], a[112:127]
    buffer_load_dwordx4 v111, s[28:31], s59 offen offset:3072  lds
    v_exp_f32 v31, v31
    v_add_f32 v113, v113, v30
    s_nop 0
    v_add_f32 v113, v113, v31
    v_cvt_pk_bf16_f32 v87, v30, v31
    s_waitcnt lgkmcnt(0)
    v_mfma_f32_32x32x16_bf16 v[16:31], a[192:195], a[128:131], v[48:63]
    v_exp_f32 v32, v32
    s_waitcnt vmcnt(12)
    ds_read_b64_tr_b16 a[224:225], v104 offset:24576
    ds_read_b64_tr_b16 a[226:227], v104 offset:26624
    s_add_u32 m0, s43, 16384
    v_mfma_f32_32x32x16_bf16 v[16:31], a[196:199], a[132:135], v[16:31]
    buffer_load_dwordx4 v112, s[32:35], s58 offen offset:0  lds
    v_exp_f32 v33, v33
    v_add_f32 v114, v114, v32
    ds_read_b64_tr_b16 a[232:233], v105 offset:24576
    ds_read_b64_tr_b16 a[234:235], v105 offset:26624
    v_mfma_f32_32x32x16_bf16 v[16:31], a[200:203], a[136:139], v[16:31]
    v_exp_f32 v34, v34
    v_add_f32 v114, v114, v33
    v_cvt_pk_bf16_f32 v88, v32, v33
    ds_read_b64_tr_b16 a[240:241], v106 offset:24576
    ds_read_b64_tr_b16 a[242:243], v106 offset:26624
    v_mfma_f32_32x32x16_bf16 v[16:31], a[204:207], a[140:143], v[16:31]
    buffer_load_dwordx4 v112, s[32:35], s58 offen offset:1024  lds
    v_exp_f32 v35, v35
    v_add_f32 v114, v114, v34
    ds_read_b64_tr_b16 a[248:249], v107 offset:24576
    ds_read_b64_tr_b16 a[250:251], v107 offset:26624
    v_mfma_f32_32x32x16_bf16 v[16:31], a[208:211], a[144:147], v[16:31]
    v_exp_f32 v36, v36
    v_add_f32 v114, v114, v35
    v_cvt_pk_bf16_f32 v89, v34, v35
    ds_read_b64_tr_b16 a[228:229], v104 offset:28672
    ds_read_b64_tr_b16 a[230:231], v104 offset:30720
    v_mfma_f32_32x32x16_bf16 v[16:31], a[212:215], a[148:151], v[16:31]
    buffer_load_dwordx4 v112, s[32:35], s58 offen offset:2048  lds
    v_exp_f32 v37, v37
    v_add_f32 v114, v114, v36
    ds_read_b64_tr_b16 a[236:237], v105 offset:28672
    ds_read_b64_tr_b16 a[238:239], v105 offset:30720
    v_mfma_f32_32x32x16_bf16 v[16:31], a[216:219], a[152:155], v[16:31]
    v_exp_f32 v38, v38
    v_add_f32 v114, v114, v37
    v_cvt_pk_bf16_f32 v90, v36, v37
    ds_read_b64_tr_b16 a[244:245], v106 offset:28672
    ds_read_b64_tr_b16 a[246:247], v106 offset:30720
    v_mfma_f32_32x32x16_bf16 v[16:31], a[220:223], a[156:159], v[16:31]
    buffer_load_dwordx4 v112, s[32:35], s58 offen offset:3072  lds
    v_exp_f32 v39, v39
    v_add_f32 v114, v114, v38
    ds_read_b64_tr_b16 a[252:253], v107 offset:28672
    ds_read_b64_tr_b16 a[254:255], v107 offset:30720
    s_waitcnt lgkmcnt(8)
    v_mfma_f32_32x32x16_bf16 v[224:239], a[224:227], v[80:83], v[224:239]
    v_exp_f32 v40, v40
    v_add_f32 v114, v114, v39
    v_cvt_pk_bf16_f32 v91, v38, v39
    s_add_u32 m0, s43, 32768
    v_mfma_f32_32x32x16_bf16 a[16:31], a[232:235], v[80:83], a[16:31]
    buffer_load_dwordx4 v108, s[28:31], s60 offen offset:0  lds
    v_exp_f32 v41, v41
    v_add_f32 v114, v114, v40
    v_mfma_f32_32x32x16_bf16 a[32:47], a[240:243], v[80:83], a[32:47]
    v_exp_f32 v42, v42
    v_add_f32 v114, v114, v41
    v_cvt_pk_bf16_f32 v92, v40, v41
    v_mfma_f32_32x32x16_bf16 a[48:63], a[248:251], v[80:83], a[48:63]
    buffer_load_dwordx4 v109, s[28:31], s60 offen offset:1024  lds
    v_exp_f32 v43, v43
    v_add_f32 v114, v114, v42
    s_waitcnt lgkmcnt(0)
    v_mfma_f32_32x32x16_bf16 v[224:239], a[228:231], v[84:87], v[224:239]
    v_exp_f32 v44, v44
    v_add_f32 v114, v114, v43
    v_cvt_pk_bf16_f32 v93, v42, v43
    v_mfma_f32_32x32x16_bf16 a[16:31], a[236:239], v[84:87], a[16:31]
    buffer_load_dwordx4 v110, s[28:31], s60 offen offset:2048  lds
    v_exp_f32 v45, v45
    v_add_f32 v114, v114, v44
    v_mfma_f32_32x32x16_bf16 a[32:47], a[244:247], v[84:87], a[32:47]
    v_exp_f32 v46, v46
    v_add_f32 v114, v114, v45
    v_cvt_pk_bf16_f32 v94, v44, v45
    v_mfma_f32_32x32x16_bf16 a[48:63], a[252:255], v[84:87], a[48:63]
    buffer_load_dwordx4 v111, s[28:31], s60 offen offset:3072  lds
    v_exp_f32 v47, v47
    v_add_f32 v114, v114, v46
    v_add_f32 v114, v114, v47
    v_cvt_pk_bf16_f32 v95, v46, v47
    v_mfma_f32_32x32x16_bf16 v[32:47], a[192:195], a[160:163], v[64:79]
    v_exp_f32 v16, v16
    s_mov_b32 m0, s42
    v_mfma_f32_32x32x16_bf16 v[32:47], a[196:199], a[164:167], v[32:47]
    buffer_load_dwordx4 v112, s[32:35], s51 offen offset:0  lds
    v_exp_f32 v17, v17
    v_add_f32 v113, v113, v16
    v_mfma_f32_32x32x16_bf16 v[32:47], a[200:203], a[168:171], v[32:47]
    v_exp_f32 v18, v18
    v_add_f32 v113, v113, v17
    v_cvt_pk_bf16_f32 v80, v16, v17
    v_mfma_f32_32x32x16_bf16 v[32:47], a[204:207], a[172:175], v[32:47]
    buffer_load_dwordx4 v112, s[32:35], s51 offen offset:1024  lds
    v_exp_f32 v19, v19
    v_add_f32 v113, v113, v18
    v_mfma_f32_32x32x16_bf16 v[32:47], a[208:211], a[176:179], v[32:47]
    v_exp_f32 v20, v20
    v_add_f32 v113, v113, v19
    v_cvt_pk_bf16_f32 v81, v18, v19
    v_mfma_f32_32x32x16_bf16 v[32:47], a[212:215], a[180:183], v[32:47]
    buffer_load_dwordx4 v112, s[32:35], s51 offen offset:2048  lds
    v_exp_f32 v21, v21
    v_add_f32 v113, v113, v20
    v_mfma_f32_32x32x16_bf16 v[32:47], a[216:219], a[184:187], v[32:47]
    v_exp_f32 v22, v22
    v_add_f32 v113, v113, v21
    v_cvt_pk_bf16_f32 v82, v20, v21
    v_mfma_f32_32x32x16_bf16 v[32:47], a[220:223], a[188:191], v[32:47]
    buffer_load_dwordx4 v112, s[32:35], s51 offen offset:3072  lds
    v_exp_f32 v23, v23
    v_add_f32 v113, v113, v22
    s_waitcnt vmcnt(12)
    v_mfma_f32_32x32x16_bf16 v[240:255], a[224:227], v[88:91], v[240:255]
    v_exp_f32 v24, v24
    v_add_f32 v113, v113, v23
    v_cvt_pk_bf16_f32 v83, v22, v23
    ds_read_b128 a[192:195], v96 offset:8192
    ds_read_b128 a[196:199], v97 offset:8192
    s_add_u32 m0, s42, 24576
    v_mfma_f32_32x32x16_bf16 a[80:95], a[232:235], v[88:91], a[80:95]
    buffer_load_dwordx4 v112, s[32:35], s53 offen offset:0  lds
    v_exp_f32 v25, v25
    v_add_f32 v113, v113, v24
    ds_read_b128 a[200:203], v98 offset:8192
    ds_read_b128 a[204:207], v99 offset:8192
    v_mfma_f32_32x32x16_bf16 a[96:111], a[240:243], v[88:91], a[96:111]
    v_exp_f32 v26, v26
    v_add_f32 v113, v113, v25
    v_cvt_pk_bf16_f32 v84, v24, v25
    ds_read_b128 a[208:211], v100 offset:8192
    ds_read_b128 a[212:215], v101 offset:8192
    v_mfma_f32_32x32x16_bf16 a[112:127], a[248:251], v[88:91], a[112:127]
    buffer_load_dwordx4 v112, s[32:35], s53 offen offset:1024  lds
    v_exp_f32 v27, v27
    v_add_f32 v113, v113, v26
    ds_read_b128 a[216:219], v102 offset:8192
    ds_read_b128 a[220:223], v103 offset:8192
    v_mfma_f32_32x32x16_bf16 v[240:255], a[228:231], v[92:95], v[240:255]
    v_exp_f32 v28, v28
    v_add_f32 v113, v113, v27
    v_cvt_pk_bf16_f32 v85, v26, v27
    v_mfma_f32_32x32x16_bf16 a[80:95], a[236:239], v[92:95], a[80:95]
    buffer_load_dwordx4 v112, s[32:35], s53 offen offset:2048  lds
    v_exp_f32 v29, v29
    v_add_f32 v113, v113, v28
    v_mfma_f32_32x32x16_bf16 a[96:111], a[244:247], v[92:95], a[96:111]
    v_exp_f32 v30, v30
    v_add_f32 v113, v113, v29
    v_cvt_pk_bf16_f32 v86, v28, v29
    v_mfma_f32_32x32x16_bf16 a[112:127], a[252:255], v[92:95], a[112:127]
    buffer_load_dwordx4 v112, s[32:35], s53 offen offset:3072  lds
    v_exp_f32 v31, v31
    v_add_f32 v113, v113, v30
    s_nop 0
    v_add_f32 v113, v113, v31
    v_cvt_pk_bf16_f32 v87, v30, v31
    s_waitcnt lgkmcnt(0)
    v_mfma_f32_32x32x16_bf16 v[16:31], a[192:195], a[128:131], v[48:63]
    v_exp_f32 v32, v32
    s_waitcnt vmcnt(12)
    ds_read_b64_tr_b16 a[224:225], v104 offset:16384
    ds_read_b64_tr_b16 a[226:227], v104 offset:18432
    v_mfma_f32_32x32x16_bf16 v[16:31], a[196:199], a[132:135], v[16:31]
    v_exp_f32 v33, v33
    v_add_f32 v114, v114, v32
    ds_read_b64_tr_b16 a[232:233], v105 offset:16384
    ds_read_b64_tr_b16 a[234:235], v105 offset:18432
    v_mfma_f32_32x32x16_bf16 v[16:31], a[200:203], a[136:139], v[16:31]
    v_exp_f32 v34, v34
    v_add_f32 v114, v114, v33
    v_cvt_pk_bf16_f32 v88, v32, v33
    ds_read_b64_tr_b16 a[240:241], v106 offset:16384
    ds_read_b64_tr_b16 a[242:243], v106 offset:18432
    v_mfma_f32_32x32x16_bf16 v[16:31], a[204:207], a[140:143], v[16:31]
    v_exp_f32 v35, v35
    v_add_f32 v114, v114, v34
    ds_read_b64_tr_b16 a[248:249], v107 offset:16384
    ds_read_b64_tr_b16 a[250:251], v107 offset:18432
    v_mfma_f32_32x32x16_bf16 v[16:31], a[208:211], a[144:147], v[16:31]
    v_exp_f32 v36, v36
    v_add_f32 v114, v114, v35
    v_cvt_pk_bf16_f32 v89, v34, v35
    ds_read_b64_tr_b16 a[228:229], v104 offset:20480
    ds_read_b64_tr_b16 a[230:231], v104 offset:22528
    v_mfma_f32_32x32x16_bf16 v[16:31], a[212:215], a[148:151], v[16:31]
    v_exp_f32 v37, v37
    v_add_f32 v114, v114, v36
    ds_read_b64_tr_b16 a[236:237], v105 offset:20480
    ds_read_b64_tr_b16 a[238:239], v105 offset:22528
    v_mfma_f32_32x32x16_bf16 v[16:31], a[216:219], a[152:155], v[16:31]
    v_exp_f32 v38, v38
    v_add_f32 v114, v114, v37
    v_cvt_pk_bf16_f32 v90, v36, v37
    ds_read_b64_tr_b16 a[244:245], v106 offset:20480
    ds_read_b64_tr_b16 a[246:247], v106 offset:22528
    v_mfma_f32_32x32x16_bf16 v[16:31], a[220:223], a[156:159], v[16:31]
    v_exp_f32 v39, v39
    v_add_f32 v114, v114, v38
    ds_read_b64_tr_b16 a[252:253], v107 offset:20480
    ds_read_b64_tr_b16 a[254:255], v107 offset:22528
    s_waitcnt lgkmcnt(8)
    v_mfma_f32_32x32x16_bf16 v[224:239], a[224:227], v[80:83], v[224:239]
    v_exp_f32 v40, v40
    v_add_f32 v114, v114, v39
    v_cvt_pk_bf16_f32 v91, v38, v39
    s_mov_b32 m0, s43
    v_mfma_f32_32x32x16_bf16 a[16:31], a[232:235], v[80:83], a[16:31]
    buffer_load_dwordx4 v112, s[32:35], s59 offen offset:0  lds
    v_exp_f32 v41, v41
    v_add_f32 v114, v114, v40
    v_mfma_f32_32x32x16_bf16 a[32:47], a[240:243], v[80:83], a[32:47]
    v_exp_f32 v42, v42
    v_add_f32 v114, v114, v41
    v_cvt_pk_bf16_f32 v92, v40, v41
    v_mfma_f32_32x32x16_bf16 a[48:63], a[248:251], v[80:83], a[48:63]
    buffer_load_dwordx4 v112, s[32:35], s59 offen offset:1024  lds
    v_exp_f32 v43, v43
    v_add_f32 v114, v114, v42
    s_waitcnt lgkmcnt(0)
    v_mfma_f32_32x32x16_bf16 v[224:239], a[228:231], v[84:87], v[224:239]
    v_exp_f32 v44, v44
    v_add_f32 v114, v114, v43
    v_cvt_pk_bf16_f32 v93, v42, v43
    v_mfma_f32_32x32x16_bf16 a[16:31], a[236:239], v[84:87], a[16:31]
    buffer_load_dwordx4 v112, s[32:35], s59 offen offset:2048  lds
    v_exp_f32 v45, v45
    v_add_f32 v114, v114, v44
    v_mfma_f32_32x32x16_bf16 a[32:47], a[244:247], v[84:87], a[32:47]
    v_exp_f32 v46, v46
    v_add_f32 v114, v114, v45
    v_cvt_pk_bf16_f32 v94, v44, v45
    v_mfma_f32_32x32x16_bf16 a[48:63], a[252:255], v[84:87], a[48:63]
    buffer_load_dwordx4 v112, s[32:35], s59 offen offset:3072  lds
    v_exp_f32 v47, v47
    v_add_f32 v114, v114, v46
    v_add_f32 v114, v114, v47
    v_cvt_pk_bf16_f32 v95, v46, v47
    v_mfma_f32_32x32x16_bf16 v[32:47], a[192:195], a[160:163], v[64:79]
    v_exp_f32 v16, v16
    s_add_u32 m0, s42, 8192
    v_mfma_f32_32x32x16_bf16 v[32:47], a[196:199], a[164:167], v[32:47]
    buffer_load_dwordx4 v108, s[28:31], s53 offen offset:0  lds
    v_exp_f32 v17, v17
    v_add_f32 v113, v113, v16
    v_mfma_f32_32x32x16_bf16 v[32:47], a[200:203], a[168:171], v[32:47]
    v_exp_f32 v18, v18
    v_add_f32 v113, v113, v17
    v_cvt_pk_bf16_f32 v80, v16, v17
    v_mfma_f32_32x32x16_bf16 v[32:47], a[204:207], a[172:175], v[32:47]
    buffer_load_dwordx4 v109, s[28:31], s53 offen offset:1024  lds
    v_exp_f32 v19, v19
    v_add_f32 v113, v113, v18
    v_mfma_f32_32x32x16_bf16 v[32:47], a[208:211], a[176:179], v[32:47]
    v_exp_f32 v20, v20
    v_add_f32 v113, v113, v19
    v_cvt_pk_bf16_f32 v81, v18, v19
    v_mfma_f32_32x32x16_bf16 v[32:47], a[212:215], a[180:183], v[32:47]
    buffer_load_dwordx4 v110, s[28:31], s53 offen offset:2048  lds
    v_exp_f32 v21, v21
    v_add_f32 v113, v113, v20
    v_mfma_f32_32x32x16_bf16 v[32:47], a[216:219], a[184:187], v[32:47]
    v_exp_f32 v22, v22
    v_add_f32 v113, v113, v21
    v_cvt_pk_bf16_f32 v82, v20, v21
    v_mfma_f32_32x32x16_bf16 v[32:47], a[220:223], a[188:191], v[32:47]
    buffer_load_dwordx4 v111, s[28:31], s53 offen offset:3072  lds
    v_exp_f32 v23, v23
    v_add_f32 v113, v113, v22
    s_waitcnt vmcnt(16)
    v_mfma_f32_32x32x16_bf16 v[240:255], a[224:227], v[88:91], v[240:255]
    v_exp_f32 v24, v24
    v_add_f32 v113, v113, v23
    v_cvt_pk_bf16_f32 v83, v22, v23
    ds_read_b128 a[192:195], v96 offset:32768
    ds_read_b128 a[196:199], v97 offset:32768
    s_add_u32 m0, s43, 8192
    v_mfma_f32_32x32x16_bf16 a[80:95], a[232:235], v[88:91], a[80:95]
    buffer_load_dwordx4 v108, s[28:31], s61 offen offset:0  lds
    v_exp_f32 v25, v25
    v_add_f32 v113, v113, v24
    ds_read_b128 a[200:203], v98 offset:32768
    ds_read_b128 a[204:207], v99 offset:32768
    v_mfma_f32_32x32x16_bf16 a[96:111], a[240:243], v[88:91], a[96:111]
    v_exp_f32 v26, v26
    v_add_f32 v113, v113, v25
    v_cvt_pk_bf16_f32 v84, v24, v25
    ds_read_b128 a[208:211], v100 offset:32768
    ds_read_b128 a[212:215], v101 offset:32768
    v_mfma_f32_32x32x16_bf16 a[112:127], a[248:251], v[88:91], a[112:127]
    buffer_load_dwordx4 v109, s[28:31], s61 offen offset:1024  lds
    v_exp_f32 v27, v27
    v_add_f32 v113, v113, v26
    ds_read_b128 a[216:219], v102 offset:32768
    ds_read_b128 a[220:223], v103 offset:32768
    v_mfma_f32_32x32x16_bf16 v[240:255], a[228:231], v[92:95], v[240:255]
    v_exp_f32 v28, v28
    v_add_f32 v113, v113, v27
    v_cvt_pk_bf16_f32 v85, v26, v27
    v_mfma_f32_32x32x16_bf16 a[80:95], a[236:239], v[92:95], a[80:95]
    buffer_load_dwordx4 v110, s[28:31], s61 offen offset:2048  lds
    v_exp_f32 v29, v29
    v_add_f32 v113, v113, v28
    v_mfma_f32_32x32x16_bf16 a[96:111], a[244:247], v[92:95], a[96:111]
    v_exp_f32 v30, v30
    v_add_f32 v113, v113, v29
    v_cvt_pk_bf16_f32 v86, v28, v29
    v_mfma_f32_32x32x16_bf16 a[112:127], a[252:255], v[92:95], a[112:127]
    buffer_load_dwordx4 v111, s[28:31], s61 offen offset:3072  lds
    v_exp_f32 v31, v31
    v_add_f32 v113, v113, v30
    s_nop 0
    v_add_f32 v113, v113, v31
    v_cvt_pk_bf16_f32 v87, v30, v31
    s_waitcnt lgkmcnt(0)
    v_mfma_f32_32x32x16_bf16 v[16:31], a[192:195], a[128:131], v[48:63]
    v_exp_f32 v32, v32
    s_waitcnt vmcnt(8)
    ds_read_b64_tr_b16 a[224:225], v104 offset:0
    ds_read_b64_tr_b16 a[226:227], v104 offset:2048
    v_mfma_f32_32x32x16_bf16 v[16:31], a[196:199], a[132:135], v[16:31]
    v_exp_f32 v33, v33
    v_add_f32 v114, v114, v32
    ds_read_b64_tr_b16 a[232:233], v105 offset:0
    ds_read_b64_tr_b16 a[234:235], v105 offset:2048
    v_mfma_f32_32x32x16_bf16 v[16:31], a[200:203], a[136:139], v[16:31]
    v_exp_f32 v34, v34
    v_add_f32 v114, v114, v33
    v_cvt_pk_bf16_f32 v88, v32, v33
    ds_read_b64_tr_b16 a[240:241], v106 offset:0
    ds_read_b64_tr_b16 a[242:243], v106 offset:2048
    v_mfma_f32_32x32x16_bf16 v[16:31], a[204:207], a[140:143], v[16:31]
    v_exp_f32 v35, v35
    v_add_f32 v114, v114, v34
    ds_read_b64_tr_b16 a[248:249], v107 offset:0
    ds_read_b64_tr_b16 a[250:251], v107 offset:2048
    v_mfma_f32_32x32x16_bf16 v[16:31], a[208:211], a[144:147], v[16:31]
    v_exp_f32 v36, v36
    v_add_f32 v114, v114, v35
    v_cvt_pk_bf16_f32 v89, v34, v35
    ds_read_b64_tr_b16 a[228:229], v104 offset:4096
    ds_read_b64_tr_b16 a[230:231], v104 offset:6144
    v_mfma_f32_32x32x16_bf16 v[16:31], a[212:215], a[148:151], v[16:31]
    v_exp_f32 v37, v37
    v_add_f32 v114, v114, v36
    ds_read_b64_tr_b16 a[236:237], v105 offset:4096
    ds_read_b64_tr_b16 a[238:239], v105 offset:6144
    v_mfma_f32_32x32x16_bf16 v[16:31], a[216:219], a[152:155], v[16:31]
    v_exp_f32 v38, v38
    v_add_f32 v114, v114, v37
    v_cvt_pk_bf16_f32 v90, v36, v37
    ds_read_b64_tr_b16 a[244:245], v106 offset:4096
    ds_read_b64_tr_b16 a[246:247], v106 offset:6144
    s_add_u32 m0, s42, 16384
    v_mfma_f32_32x32x16_bf16 v[16:31], a[220:223], a[156:159], v[16:31]
    buffer_load_dwordx4 v112, s[32:35], s52 offen offset:0  lds
    v_exp_f32 v39, v39
    v_add_f32 v114, v114, v38
    ds_read_b64_tr_b16 a[252:253], v107 offset:4096
    ds_read_b64_tr_b16 a[254:255], v107 offset:6144
    s_waitcnt lgkmcnt(8)
    v_mfma_f32_32x32x16_bf16 v[224:239], a[224:227], v[80:83], v[224:239]
    v_exp_f32 v40, v40
    v_add_f32 v114, v114, v39
    v_cvt_pk_bf16_f32 v91, v38, v39
    v_mfma_f32_32x32x16_bf16 a[16:31], a[232:235], v[80:83], a[16:31]
    buffer_load_dwordx4 v112, s[32:35], s52 offen offset:1024  lds
    v_exp_f32 v41, v41
    v_add_f32 v114, v114, v40
    v_mfma_f32_32x32x16_bf16 a[32:47], a[240:243], v[80:83], a[32:47]
    v_exp_f32 v42, v42
    v_add_f32 v114, v114, v41
    v_cvt_pk_bf16_f32 v92, v40, v41
    v_mfma_f32_32x32x16_bf16 a[48:63], a[248:251], v[80:83], a[48:63]
    buffer_load_dwordx4 v112, s[32:35], s52 offen offset:2048  lds
    v_exp_f32 v43, v43
    v_add_f32 v114, v114, v42
    s_waitcnt lgkmcnt(0)
    v_mfma_f32_32x32x16_bf16 v[224:239], a[228:231], v[84:87], v[224:239]
    v_exp_f32 v44, v44
    v_add_f32 v114, v114, v43
    v_cvt_pk_bf16_f32 v93, v42, v43
    v_mfma_f32_32x32x16_bf16 a[16:31], a[236:239], v[84:87], a[16:31]
    buffer_load_dwordx4 v112, s[32:35], s52 offen offset:3072  lds
    v_exp_f32 v45, v45
    v_add_f32 v114, v114, v44
    v_mfma_f32_32x32x16_bf16 a[32:47], a[244:247], v[84:87], a[32:47]
    v_exp_f32 v46, v46
    v_add_f32 v114, v114, v45
    v_cvt_pk_bf16_f32 v94, v44, v45
    s_add_u32 m0, s43, 16384
    v_mfma_f32_32x32x16_bf16 a[48:63], a[252:255], v[84:87], a[48:63]
    buffer_load_dwordx4 v112, s[32:35], s60 offen offset:0  lds
    v_exp_f32 v47, v47
    v_add_f32 v114, v114, v46
    v_add_f32 v114, v114, v47
    v_cvt_pk_bf16_f32 v95, v46, v47
    v_mfma_f32_32x32x16_bf16 v[32:47], a[192:195], a[160:163], v[64:79]
    v_exp_f32 v16, v16
    v_mfma_f32_32x32x16_bf16 v[32:47], a[196:199], a[164:167], v[32:47]
    buffer_load_dwordx4 v112, s[32:35], s60 offen offset:1024  lds
    v_exp_f32 v17, v17
    v_add_f32 v113, v113, v16
    v_mfma_f32_32x32x16_bf16 v[32:47], a[200:203], a[168:171], v[32:47]
    v_exp_f32 v18, v18
    v_add_f32 v113, v113, v17
    v_cvt_pk_bf16_f32 v80, v16, v17
    v_mfma_f32_32x32x16_bf16 v[32:47], a[204:207], a[172:175], v[32:47]
    buffer_load_dwordx4 v112, s[32:35], s60 offen offset:2048  lds
    v_exp_f32 v19, v19
    v_add_f32 v113, v113, v18
    v_mfma_f32_32x32x16_bf16 v[32:47], a[208:211], a[176:179], v[32:47]
    v_exp_f32 v20, v20
    v_add_f32 v113, v113, v19
    v_cvt_pk_bf16_f32 v81, v18, v19
    v_mfma_f32_32x32x16_bf16 v[32:47], a[212:215], a[180:183], v[32:47]
    buffer_load_dwordx4 v112, s[32:35], s60 offen offset:3072  lds
    v_exp_f32 v21, v21
    v_add_f32 v113, v113, v20
    v_mfma_f32_32x32x16_bf16 v[32:47], a[216:219], a[184:187], v[32:47]
    v_exp_f32 v22, v22
    v_add_f32 v113, v113, v21
    v_cvt_pk_bf16_f32 v82, v20, v21
    v_mfma_f32_32x32x16_bf16 v[32:47], a[220:223], a[188:191], v[32:47]
    v_exp_f32 v23, v23
    v_add_f32 v113, v113, v22
    s_waitcnt vmcnt(8)
    v_mfma_f32_32x32x16_bf16 v[240:255], a[224:227], v[88:91], v[240:255]
    v_exp_f32 v24, v24
    v_add_f32 v113, v113, v23
    v_cvt_pk_bf16_f32 v83, v22, v23
    ds_read_b128 a[192:195], v96 offset:8192
    ds_read_b128 a[196:199], v97 offset:8192
    s_add_u32 m0, s43, 24576
    v_mfma_f32_32x32x16_bf16 a[80:95], a[232:235], v[88:91], a[80:95]
    buffer_load_dwordx4 v112, s[32:35], s61 offen offset:0  lds
    v_exp_f32 v25, v25
    v_add_f32 v113, v113, v24
    ds_read_b128 a[200:203], v98 offset:8192
    ds_read_b128 a[204:207], v99 offset:8192
    v_mfma_f32_32x32x16_bf16 a[96:111], a[240:243], v[88:91], a[96:111]
    v_exp_f32 v26, v26
    v_add_f32 v113, v113, v25
    v_cvt_pk_bf16_f32 v84, v24, v25
    ds_read_b128 a[208:211], v100 offset:8192
    ds_read_b128 a[212:215], v101 offset:8192
    v_mfma_f32_32x32x16_bf16 a[112:127], a[248:251], v[88:91], a[112:127]
    buffer_load_dwordx4 v112, s[32:35], s61 offen offset:1024  lds
    v_exp_f32 v27, v27
    v_add_f32 v113, v113, v26
    ds_read_b128 a[216:219], v102 offset:8192
    ds_read_b128 a[220:223], v103 offset:8192
    v_mfma_f32_32x32x16_bf16 v[240:255], a[228:231], v[92:95], v[240:255]
    v_exp_f32 v28, v28
    v_add_f32 v113, v113, v27
    v_cvt_pk_bf16_f32 v85, v26, v27
    v_mfma_f32_32x32x16_bf16 a[80:95], a[236:239], v[92:95], a[80:95]
    buffer_load_dwordx4 v112, s[32:35], s61 offen offset:2048  lds
    v_exp_f32 v29, v29
    v_add_f32 v113, v113, v28
    v_mfma_f32_32x32x16_bf16 a[96:111], a[244:247], v[92:95], a[96:111]
    v_exp_f32 v30, v30
    v_add_f32 v113, v113, v29
    v_cvt_pk_bf16_f32 v86, v28, v29
    v_mfma_f32_32x32x16_bf16 a[112:127], a[252:255], v[92:95], a[112:127]
    buffer_load_dwordx4 v112, s[32:35], s61 offen offset:3072  lds
    v_exp_f32 v31, v31
    v_add_f32 v113, v113, v30
    s_nop 0
    v_add_f32 v113, v113, v31
    v_cvt_pk_bf16_f32 v87, v30, v31
    s_waitcnt lgkmcnt(0)
    v_mfma_f32_32x32x16_bf16 v[16:31], a[192:195], a[128:131], v[48:63]
    v_exp_f32 v32, v32
    s_waitcnt vmcnt(4)
    ds_read_b64_tr_b16 a[232:233], v105 offset:16384
    ds_read_b64_tr_b16 a[234:235], v105 offset:18432
    v_mfma_f32_32x32x16_bf16 v[16:31], a[196:199], a[132:135], v[16:31]
    v_exp_f32 v33, v33
    v_add_f32 v114, v114, v32
    ds_read_b64_tr_b16 a[236:237], v105 offset:20480
    ds_read_b64_tr_b16 a[238:239], v105 offset:22528
    v_mfma_f32_32x32x16_bf16 v[16:31], a[200:203], a[136:139], v[16:31]
    v_exp_f32 v34, v34
    v_add_f32 v114, v114, v33
    v_cvt_pk_bf16_f32 v88, v32, v33
    ds_read_b64_tr_b16 a[240:241], v106 offset:16384
    ds_read_b64_tr_b16 a[242:243], v106 offset:18432
    v_mfma_f32_32x32x16_bf16 v[16:31], a[204:207], a[140:143], v[16:31]
    v_exp_f32 v35, v35
    v_add_f32 v114, v114, v34
    ds_read_b64_tr_b16 a[244:245], v106 offset:20480
    ds_read_b64_tr_b16 a[246:247], v106 offset:22528
    v_mfma_f32_32x32x16_bf16 v[16:31], a[208:211], a[144:147], v[16:31]
    v_exp_f32 v36, v36
    v_add_f32 v114, v114, v35
    v_cvt_pk_bf16_f32 v89, v34, v35
    ds_read_b64_tr_b16 a[248:249], v107 offset:16384
    ds_read_b64_tr_b16 a[250:251], v107 offset:18432
    v_mfma_f32_32x32x16_bf16 v[16:31], a[212:215], a[148:151], v[16:31]
    v_exp_f32 v37, v37
    v_add_f32 v114, v114, v36
    ds_read_b64_tr_b16 a[252:253], v107 offset:20480
    ds_read_b64_tr_b16 a[254:255], v107 offset:22528
    v_mfma_f32_32x32x16_bf16 v[16:31], a[216:219], a[152:155], v[16:31]
    v_exp_f32 v38, v38
    v_add_f32 v114, v114, v37
    v_cvt_pk_bf16_f32 v90, v36, v37
    ds_read_b64_tr_b16 a[224:225], v104 offset:16384
    ds_read_b64_tr_b16 a[226:227], v104 offset:18432
    v_mfma_f32_32x32x16_bf16 v[16:31], a[220:223], a[156:159], v[16:31]
    v_exp_f32 v39, v39
    v_add_f32 v114, v114, v38
    ds_read_b64_tr_b16 a[228:229], v104 offset:20480
    ds_read_b64_tr_b16 a[230:231], v104 offset:22528
    s_waitcnt lgkmcnt(8)
    v_mfma_f32_32x32x16_bf16 a[16:31], a[232:235], v[80:83], a[16:31]
    v_exp_f32 v40, v40
    v_add_f32 v114, v114, v39
    v_cvt_pk_bf16_f32 v91, v38, v39
    v_mfma_f32_32x32x16_bf16 a[16:31], a[236:239], v[84:87], a[16:31]
    v_exp_f32 v41, v41
    v_add_f32 v114, v114, v40
    v_mfma_f32_32x32x16_bf16 a[32:47], a[240:243], v[80:83], a[32:47]
    v_exp_f32 v42, v42
    v_add_f32 v114, v114, v41
    v_cvt_pk_bf16_f32 v92, v40, v41
    v_mfma_f32_32x32x16_bf16 a[32:47], a[244:247], v[84:87], a[32:47]
    v_exp_f32 v43, v43
    v_add_f32 v114, v114, v42
    ds_write_b128 v120, a[16:19] offset:0
    s_waitcnt lgkmcnt(1)
    v_mfma_f32_32x32x16_bf16 a[48:63], a[248:251], v[80:83], a[48:63]
    v_exp_f32 v44, v44
    v_add_f32 v114, v114, v43
    v_cvt_pk_bf16_f32 v93, v42, v43
    ds_write_b128 v120, a[20:23] offset:1024
    v_mfma_f32_32x32x16_bf16 a[48:63], a[252:255], v[84:87], a[48:63]
    v_exp_f32 v45, v45
    v_add_f32 v114, v114, v44
    ds_write_b128 v120, a[24:27] offset:2048
    v_mfma_f32_32x32x16_bf16 v[224:239], a[224:227], v[80:83], v[224:239]
    v_exp_f32 v46, v46
    v_add_f32 v114, v114, v45
    v_cvt_pk_bf16_f32 v94, v44, v45
    v_mfma_f32_32x32x16_bf16 v[224:239], a[228:231], v[84:87], v[224:239]
    v_exp_f32 v47, v47
    v_add_f32 v114, v114, v46
    ds_write_b128 v120, a[28:31] offset:3072
    v_add_f32 v114, v114, v47
    v_cvt_pk_bf16_f32 v95, v46, v47
    v_mfma_f32_32x32x16_bf16 v[32:47], a[192:195], a[160:163], v[64:79]
    v_exp_f32 v16, v16
    ds_write_b128 v120, a[32:35] offset:4096
    v_mfma_f32_32x32x16_bf16 v[32:47], a[196:199], a[164:167], v[32:47]
    v_exp_f32 v17, v17
    v_add_f32 v113, v113, v16
    ds_write_b128 v120, a[36:39] offset:5120
    v_mfma_f32_32x32x16_bf16 v[32:47], a[200:203], a[168:171], v[32:47]
    v_exp_f32 v18, v18
    v_add_f32 v113, v113, v17
    v_cvt_pk_bf16_f32 v80, v16, v17
    v_mfma_f32_32x32x16_bf16 v[32:47], a[204:207], a[172:175], v[32:47]
    v_exp_f32 v19, v19
    v_add_f32 v113, v113, v18
    ds_write_b128 v120, a[40:43] offset:6144
    v_mfma_f32_32x32x16_bf16 v[32:47], a[208:211], a[176:179], v[32:47]
    v_exp_f32 v20, v20
    v_add_f32 v113, v113, v19
    v_cvt_pk_bf16_f32 v81, v18, v19
    ds_write_b128 v120, a[44:47] offset:7168
    v_mfma_f32_32x32x16_bf16 v[32:47], a[212:215], a[180:183], v[32:47]
    v_exp_f32 v21, v21
    v_add_f32 v113, v113, v20
    ds_write_b128 v120, a[48:51] offset:8192
    v_mfma_f32_32x32x16_bf16 v[32:47], a[216:219], a[184:187], v[32:47]
    v_exp_f32 v22, v22
    v_add_f32 v113, v113, v21
    v_cvt_pk_bf16_f32 v82, v20, v21
    v_mfma_f32_32x32x16_bf16 v[32:47], a[220:223], a[188:191], v[32:47]
    v_exp_f32 v23, v23
    v_add_f32 v113, v113, v22
    ds_write_b128 v120, a[52:55] offset:9216
    v_mfma_f32_32x32x16_bf16 a[80:95], a[232:235], v[88:91], a[80:95]
    v_exp_f32 v24, v24
    v_add_f32 v113, v113, v23
    v_cvt_pk_bf16_f32 v83, v22, v23
    ds_write_b128 v120, a[56:59] offset:10240
    v_mfma_f32_32x32x16_bf16 a[80:95], a[236:239], v[92:95], a[80:95]
    v_exp_f32 v25, v25
    v_add_f32 v113, v113, v24
    ds_write_b128 v120, a[60:63] offset:11264
    v_mfma_f32_32x32x16_bf16 a[96:111], a[240:243], v[88:91], a[96:111]
    v_exp_f32 v26, v26
    v_add_f32 v113, v113, v25
    v_cvt_pk_bf16_f32 v84, v24, v25
    v_mfma_f32_32x32x16_bf16 a[96:111], a[244:247], v[92:95], a[96:111]
    v_exp_f32 v27, v27
    v_add_f32 v113, v113, v26
    ds_write_b128 v120, v[80:83] offset:32768
    v_mfma_f32_32x32x16_bf16 a[112:127], a[248:251], v[88:91], a[112:127]
    v_exp_f32 v28, v28
    v_add_f32 v113, v113, v27
    v_cvt_pk_bf16_f32 v85, v26, v27
    ds_write_b128 v120, a[80:83] offset:12288
    v_mfma_f32_32x32x16_bf16 a[112:127], a[252:255], v[92:95], a[112:127]
    v_exp_f32 v29, v29
    v_add_f32 v113, v113, v28
    ds_write_b128 v120, a[84:87] offset:13312
    v_mfma_f32_32x32x16_bf16 v[240:255], a[224:227], v[88:91], v[240:255]
    v_exp_f32 v30, v30
    v_add_f32 v113, v113, v29
    v_cvt_pk_bf16_f32 v86, v28, v29
    ds_write_b128 v120, a[88:91] offset:14336
    v_mfma_f32_32x32x16_bf16 v[240:255], a[228:231], v[92:95], v[240:255]
    v_exp_f32 v31, v31
    v_add_f32 v113, v113, v30
    ds_write_b128 v120, a[92:95] offset:15360
    s_nop 0
    v_add_f32 v113, v113, v31
    v_cvt_pk_bf16_f32 v87, v30, v31
    v_mov_b32 v60, v113
    ds_write_b128 v120, v[84:87] offset:33792
    v_mov_b32 v16, v48
    v_mov_b32 v18, v64
    v_permlane32_swap_b32 v60, v113
    v_add_f32 v17, v60, v113
    ds_write_b128 v120, v[16:19] offset:36864
    s_waitcnt vmcnt(0)
    ds_read_b64_tr_b16 a[224:225], v104 offset:24576
    ds_read_b64_tr_b16 a[226:227], v104 offset:26624
    ds_read_b64_tr_b16 a[228:229], v104 offset:28672
    ds_read_b64_tr_b16 a[230:231], v104 offset:30720
    v_exp_f32 v32, v32
    v_exp_f32 v33, v33
    v_add_f32 v114, v114, v32
    v_exp_f32 v34, v34
    v_add_f32 v114, v114, v33
    v_cvt_pk_bf16_f32 v88, v32, v33
    v_exp_f32 v35, v35
    v_add_f32 v114, v114, v34
    s_waitcnt lgkmcnt(4)
    s_barrier
    ds_read_b128 v[20:23], v121 offset:36864
    ds_read_b128 v[24:27], v122 offset:36864
    ds_read_b128 v[28:31], v123 offset:36864
    ds_read_b64_tr_b16 a[232:233], v125 offset:24576
    ds_read_b64_tr_b16 a[234:235], v125 offset:26624
    ds_read_b64_tr_b16 a[236:237], v125 offset:28672
    ds_read_b64_tr_b16 a[238:239], v125 offset:30720
    ds_read_b128 a[0:3], v121 offset:32768
    ds_read_b128 a[4:7], v121 offset:33792
    ds_read_b128 v[128:131], v121 offset:0
    ds_read_b128 v[132:135], v121 offset:1024
    ds_read_b128 v[136:139], v121 offset:2048
    ds_read_b128 v[140:143], v121 offset:3072
    s_waitcnt lgkmcnt(13)
    v_mfma_f32_32x32x16_bf16 v[224:239], a[224:227], v[80:83], v[224:239]
    ds_read_b64_tr_b16 a[240:241], v126 offset:24576
    ds_read_b64_tr_b16 a[242:243], v126 offset:26624
    ds_read_b64_tr_b16 a[244:245], v126 offset:28672
    ds_read_b64_tr_b16 a[246:247], v126 offset:30720
    v_exp_f32 v36, v36
    v_add_f32 v114, v114, v35
    v_cvt_pk_bf16_f32 v89, v34, v35
    v_mfma_f32_32x32x16_bf16 v[224:239], a[228:231], v[84:87], v[224:239]
    ds_read_b128 a[8:11], v122 offset:32768
    ds_read_b128 a[12:15], v122 offset:33792
    ds_read_b128 v[144:147], v122 offset:4096
    ds_read_b128 v[148:151], v122 offset:5120
    ds_read_b128 v[152:155], v122 offset:6144
    ds_read_b128 v[156:159], v122 offset:7168
    v_exp_f32 v37, v37
    v_add_f32 v114, v114, v36
    v_exp_f32 v38, v38
    v_add_f32 v114, v114, v37
    v_cvt_pk_bf16_f32 v90, v36, v37
    s_waitcnt lgkmcnt(10)
    v_mfma_f32_32x32x16_bf16 v[128:143], a[232:235], a[0:3], v[128:143]
    ds_read_b64_tr_b16 a[248:249], v127 offset:24576
    ds_read_b64_tr_b16 a[250:251], v127 offset:26624
    ds_read_b64_tr_b16 a[252:253], v127 offset:28672
    ds_read_b64_tr_b16 a[254:255], v127 offset:30720
    v_exp_f32 v39, v39
    v_add_f32 v114, v114, v38
    v_mfma_f32_32x32x16_bf16 v[128:143], a[236:239], a[4:7], v[128:143]
    ds_read_b128 a[64:67], v123 offset:32768
    ds_read_b128 a[68:71], v123 offset:33792
    ds_read_b128 v[160:163], v123 offset:8192
    ds_read_b128 v[164:167], v123 offset:9216
    ds_read_b128 v[168:171], v123 offset:10240
    ds_read_b128 v[172:175], v123 offset:11264
    v_exp_f32 v40, v40
    v_add_f32 v114, v114, v39
    v_cvt_pk_bf16_f32 v91, v38, v39
    v_exp_f32 v41, v41
    v_add_f32 v114, v114, v40
    s_waitcnt lgkmcnt(10)
    v_mfma_f32_32x32x16_bf16 v[144:159], a[240:243], a[8:11], v[144:159]
    v_exp_f32 v42, v42
    v_add_f32 v114, v114, v41
    v_cvt_pk_bf16_f32 v92, v40, v41
    ds_write_b128 v120, a[96:99] offset:16384
    v_mfma_f32_32x32x16_bf16 v[144:159], a[244:247], a[12:15], v[144:159]
    v_exp_f32 v43, v43
    v_add_f32 v114, v114, v42
    ds_write_b128 v120, a[100:103] offset:17408
    v_exp_f32 v44, v44
    v_add_f32 v114, v114, v43
    v_cvt_pk_bf16_f32 v93, v42, v43
    s_waitcnt lgkmcnt(2)
    v_mfma_f32_32x32x16_bf16 v[160:175], a[248:251], a[64:67], v[160:175]
    ds_write_b128 v120, a[104:107] offset:18432
    v_exp_f32 v45, v45
    v_add_f32 v114, v114, v44
    v_mfma_f32_32x32x16_bf16 v[160:175], a[252:255], a[68:71], v[160:175]
    ds_write_b128 v120, a[108:111] offset:19456
    v_exp_f32 v46, v46
    v_add_f32 v114, v114, v45
    v_cvt_pk_bf16_f32 v94, v44, v45
    ds_write_b128 v120, a[112:115] offset:20480
    v_exp_f32 v47, v47
    v_add_f32 v114, v114, v46
    ds_write_b128 v120, a[116:119] offset:21504
    s_nop 0
    v_add_f32 v114, v114, v47
    v_cvt_pk_bf16_f32 v95, v46, v47
    v_mov_b32 v61, v114
    ds_write_b128 v120, v[88:91] offset:34816
    v_mfma_f32_32x32x16_bf16 v[240:255], a[224:227], v[88:91], v[240:255]
    ds_write_b128 v120, v[92:95] offset:35840
    v_permlane32_swap_b32 v61, v114
    v_add_f32 v19, v61, v114
    v_mfma_f32_32x32x16_bf16 v[240:255], a[228:231], v[92:95], v[240:255]
    ds_write_b32 v120, v19 offset:36876
    ds_write_b128 v120, a[120:123] offset:22528
    v_min3_f32 v48, v16, v20, v24
    v_min_f32 v48, v48, v28
    v_sub_f32 v52, v48, v16
    v_sub_f32 v53, v48, v20
    v_sub_f32 v54, v48, v24
    ds_write_b128 v120, a[124:127] offset:23552
    v_sub_f32 v55, v48, v28
    v_exp_f32 v52, v52
    v_exp_f32 v53, v53
    v_exp_f32 v54, v54
    v_exp_f32 v55, v55
    v_min3_f32 v50, v18, v22, v26
    v_min_f32 v50, v50, v30
    v_sub_f32 v56, v50, v18
    v_sub_f32 v57, v50, v22
    v_sub_f32 v58, v50, v26
    v_sub_f32 v59, v50, v30
    v_exp_f32 v56, v56
    v_exp_f32 v57, v57
    v_exp_f32 v58, v58
    v_exp_f32 v59, v59
    v_mul_f32 v49, v52, v17
    v_fma_f32 v49, v53, v21, v49
    v_fma_f32 v49, v54, v25, v49
    v_fma_f32 v49, v55, v29, v49
    v_rcp_f32 v49, v49
    s_nop 0
    v_mul_f32 v52, v52, v49
    v_mul_f32 v53, v53, v49
    v_mul_f32 v54, v54, v49
    v_mul_f32 v55, v55, v49
    s_mov_b32 s17, 0x5d800000
    v_max3_u32 v60, v17, v19, v21
    v_max3_u32 v60, v60, v25, v29
    s_waitcnt lgkmcnt(0)
    s_barrier
    ds_read_b128 a[72:75], v121 offset:34816
    ds_read_b128 a[76:79], v121 offset:35840
    ds_read_b128 v[176:179], v121 offset:12288
    ds_read_b128 v[180:183], v121 offset:13312
    ds_read_b128 v[184:187], v121 offset:14336
    ds_read_b128 v[188:191], v121 offset:15360
    ds_read_b32 v23, v121 offset:36876
    ds_read_b32 v27, v122 offset:36876
    ds_read_b32 v31, v123 offset:36876
    ds_read_b128 a[192:195], v122 offset:34816
    ds_read_b128 a[196:199], v122 offset:35840
    ds_read_b128 v[192:195], v122 offset:16384
    ds_read_b128 v[196:199], v122 offset:17408
    ds_read_b128 v[200:203], v122 offset:18432
    ds_read_b128 v[204:207], v122 offset:19456
    v_pk_mul_f32 v[224:225], v[224:225], v[52:53] op_sel:[0,0] op_sel_hi:[1,0]
    v_pk_mul_f32 v[226:227], v[226:227], v[52:53] op_sel:[0,0] op_sel_hi:[1,0]
    v_pk_mul_f32 v[228:229], v[228:229], v[52:53] op_sel:[0,0] op_sel_hi:[1,0]
    v_pk_mul_f32 v[230:231], v[230:231], v[52:53] op_sel:[0,0] op_sel_hi:[1,0]
    v_pk_mul_f32 v[232:233], v[232:233], v[52:53] op_sel:[0,0] op_sel_hi:[1,0]
    v_pk_mul_f32 v[234:235], v[234:235], v[52:53] op_sel:[0,0] op_sel_hi:[1,0]
    v_pk_mul_f32 v[236:237], v[236:237], v[52:53] op_sel:[0,0] op_sel_hi:[1,0]
    v_pk_mul_f32 v[238:239], v[238:239], v[52:53] op_sel:[0,0] op_sel_hi:[1,0]
    v_pk_fma_f32 v[224:225], v[128:129], v[52:53], v[224:225] op_sel:[0,1,0] op_sel_hi:[1,1,1]
    v_pk_fma_f32 v[226:227], v[130:131], v[52:53], v[226:227] op_sel:[0,1,0] op_sel_hi:[1,1,1]
    v_pk_fma_f32 v[228:229], v[132:133], v[52:53], v[228:229] op_sel:[0,1,0] op_sel_hi:[1,1,1]
    v_pk_fma_f32 v[230:231], v[134:135], v[52:53], v[230:231] op_sel:[0,1,0] op_sel_hi:[1,1,1]
    v_pk_fma_f32 v[232:233], v[136:137], v[52:53], v[232:233] op_sel:[0,1,0] op_sel_hi:[1,1,1]
    v_pk_fma_f32 v[234:235], v[138:139], v[52:53], v[234:235] op_sel:[0,1,0] op_sel_hi:[1,1,1]
    v_pk_fma_f32 v[236:237], v[140:141], v[52:53], v[236:237] op_sel:[0,1,0] op_sel_hi:[1,1,1]
    v_pk_fma_f32 v[238:239], v[142:143], v[52:53], v[238:239] op_sel:[0,1,0] op_sel_hi:[1,1,1]
    v_pk_fma_f32 v[224:225], v[144:145], v[54:55], v[224:225] op_sel:[0,0,0] op_sel_hi:[1,0,1]
    v_pk_fma_f32 v[226:227], v[146:147], v[54:55], v[226:227] op_sel:[0,0,0] op_sel_hi:[1,0,1]
    v_pk_fma_f32 v[228:229], v[148:149], v[54:55], v[228:229] op_sel:[0,0,0] op_sel_hi:[1,0,1]
    v_pk_fma_f32 v[230:231], v[150:151], v[54:55], v[230:231] op_sel:[0,0,0] op_sel_hi:[1,0,1]
    v_pk_fma_f32 v[232:233], v[152:153], v[54:55], v[232:233] op_sel:[0,0,0] op_sel_hi:[1,0,1]
    v_pk_fma_f32 v[234:235], v[154:155], v[54:55], v[234:235] op_sel:[0,0,0] op_sel_hi:[1,0,1]
    v_pk_fma_f32 v[236:237], v[156:157], v[54:55], v[236:237] op_sel:[0,0,0] op_sel_hi:[1,0,1]
    v_pk_fma_f32 v[238:239], v[158:159], v[54:55], v[238:239] op_sel:[0,0,0] op_sel_hi:[1,0,1]
    v_pk_fma_f32 v[224:225], v[160:161], v[54:55], v[224:225] op_sel:[0,1,0] op_sel_hi:[1,1,1]
    v_pk_fma_f32 v[226:227], v[162:163], v[54:55], v[226:227] op_sel:[0,1,0] op_sel_hi:[1,1,1]
    v_pk_fma_f32 v[228:229], v[164:165], v[54:55], v[228:229] op_sel:[0,1,0] op_sel_hi:[1,1,1]
    v_pk_fma_f32 v[230:231], v[166:167], v[54:55], v[230:231] op_sel:[0,1,0] op_sel_hi:[1,1,1]
    v_pk_fma_f32 v[232:233], v[168:169], v[54:55], v[232:233] op_sel:[0,1,0] op_sel_hi:[1,1,1]
    v_pk_fma_f32 v[234:235], v[170:171], v[54:55], v[234:235] op_sel:[0,1,0] op_sel_hi:[1,1,1]
    v_pk_fma_f32 v[236:237], v[172:173], v[54:55], v[236:237] op_sel:[0,1,0] op_sel_hi:[1,1,1]
    v_pk_fma_f32 v[238:239], v[174:175], v[54:55], v[238:239] op_sel:[0,1,0] op_sel_hi:[1,1,1]
    s_waitcnt lgkmcnt(9)
    v_mfma_f32_32x32x16_bf16 v[176:191], a[232:235], a[72:75], v[176:191]
    ds_read_b128 a[200:203], v123 offset:34816
    ds_read_b128 a[204:207], v123 offset:35840
    ds_read_b128 v[208:211], v123 offset:20480
    ds_read_b128 v[212:215], v123 offset:21504
    ds_read_b128 v[216:219], v123 offset:22528
    ds_read_b128 v[220:223], v123 offset:23552
    v_mfma_f32_32x32x16_bf16 v[176:191], a[236:239], a[76:79], v[176:191]
    v_cvt_pk_bf16_f32 v32, v224, v225
    v_cvt_pk_bf16_f32 v34, v228, v229
    v_cvt_pk_bf16_f32 v33, v226, v227
    v_cvt_pk_bf16_f32 v35, v230, v231
    v_cvt_pk_bf16_f32 v36, v232, v233
    v_cvt_pk_bf16_f32 v38, v236, v237
    v_cvt_pk_bf16_f32 v37, v234, v235
    v_cvt_pk_bf16_f32 v39, v238, v239
    v_permlane32_swap_b32 v32, v34
    v_permlane32_swap_b32 v33, v35
    buffer_store_dwordx4 v[32:35], v124, s[36:39], s24 offen offset:0
    s_waitcnt lgkmcnt(6)
    v_mfma_f32_32x32x16_bf16 v[192:207], a[240:243], a[192:195], v[192:207]
    v_permlane32_swap_b32 v36, v38
    v_permlane32_swap_b32 v37, v39
    buffer_store_dwordx4 v[36:39], v124, s[36:39], s24 offen offset:32
    v_mul_f32 v51, v56, v19
    v_fma_f32 v51, v57, v23, v51
    v_fma_f32 v51, v58, v27, v51
    v_fma_f32 v51, v59, v31, v51
    v_rcp_f32 v51, v51
    v_mfma_f32_32x32x16_bf16 v[192:207], a[244:247], a[196:199], v[192:207]
    v_mul_f32 v56, v56, v51
    v_mul_f32 v57, v57, v51
    v_mul_f32 v58, v58, v51
    v_mul_f32 v59, v59, v51
    v_max3_u32 v60, v60, v23, v27
    v_max_u32 v60, v60, v31
    v_cmp_le_u32 vcc, s17, v60
    s_cmp_eq_u32 s40, 0
    s_waitcnt lgkmcnt(0)
    v_mfma_f32_32x32x16_bf16 v[208:223], a[248:251], a[200:203], v[208:223]
    v_mul_f32 v240, v240, v56
    v_mul_f32 v241, v241, v56
    v_mul_f32 v242, v242, v56
    v_mul_f32 v243, v243, v56
    v_mul_f32 v244, v244, v56
    v_mul_f32 v245, v245, v56
    v_mfma_f32_32x32x16_bf16 v[208:223], a[252:255], a[204:207], v[208:223]
    s_cselect_b64 vcc, vcc, 0
    v_mul_f32 v246, v246, v56
    v_mul_f32 v247, v247, v56
    v_mul_f32 v248, v248, v56
    v_mul_f32 v249, v249, v56
    v_mul_f32 v250, v250, v56
    v_mul_f32 v251, v251, v56
    v_mul_f32 v252, v252, v56
    v_mul_f32 v253, v253, v56
    v_mul_f32 v254, v254, v56
    v_mul_f32 v255, v255, v56
    s_cbranch_vccnz L_slow
    v_pk_fma_f32 v[240:241], v[176:177], v[56:57], v[240:241] op_sel:[0,1,0] op_sel_hi:[1,1,1]
    v_pk_fma_f32 v[242:243], v[178:179], v[56:57], v[242:243] op_sel:[0,1,0] op_sel_hi:[1,1,1]
    v_pk_fma_f32 v[244:245], v[180:181], v[56:57], v[244:245] op_sel:[0,1,0] op_sel_hi:[1,1,1]
    v_pk_fma_f32 v[246:247], v[182:183], v[56:57], v[246:247] op_sel:[0,1,0] op_sel_hi:[1,1,1]
    v_pk_fma_f32 v[240:241], v[192:193], v[58:59], v[240:241] op_sel:[0,0,0] op_sel_hi:[1,0,1]
    v_pk_fma_f32 v[242:243], v[194:195], v[58:59], v[242:243] op_sel:[0,0,0] op_sel_hi:[1,0,1]
    v_pk_fma_f32 v[244:245], v[196:197], v[58:59], v[244:245] op_sel:[0,0,0] op_sel_hi:[1,0,1]
    v_pk_fma_f32 v[246:247], v[198:199], v[58:59], v[246:247] op_sel:[0,0,0] op_sel_hi:[1,0,1]
    v_pk_fma_f32 v[240:241], v[208:209], v[58:59], v[240:241] op_sel:[0,1,0] op_sel_hi:[1,1,1]
    v_pk_fma_f32 v[242:243], v[210:211], v[58:59], v[242:243] op_sel:[0,1,0] op_sel_hi:[1,1,1]
    v_pk_fma_f32 v[244:245], v[212:213], v[58:59], v[244:245] op_sel:[0,1,0] op_sel_hi:[1,1,1]
    v_pk_fma_f32 v[246:247], v[214:215], v[58:59], v[246:247] op_sel:[0,1,0] op_sel_hi:[1,1,1]
    v_cvt_pk_bf16_f32 v40, v240, v241
    v_cvt_pk_bf16_f32 v42, v244, v245
    v_cvt_pk_bf16_f32 v41, v242, v243
    v_cvt_pk_bf16_f32 v43, v246, v247
    v_pk_fma_f32 v[248:249], v[184:185], v[56:57], v[248:249] op_sel:[0,1,0] op_sel_hi:[1,1,1]
    v_pk_fma_f32 v[250:251], v[186:187], v[56:57], v[250:251] op_sel:[0,1,0] op_sel_hi:[1,1,1]
    v_pk_fma_f32 v[252:253], v[188:189], v[56:57], v[252:253] op_sel:[0,1,0] op_sel_hi:[1,1,1]
    v_pk_fma_f32 v[254:255], v[190:191], v[56:57], v[254:255] op_sel:[0,1,0] op_sel_hi:[1,1,1]
    v_permlane32_swap_b32 v40, v42
    v_permlane32_swap_b32 v41, v43
    buffer_store_dwordx4 v[40:43], v124, s[36:39], s23 offen offset:0
    v_pk_fma_f32 v[248:249], v[200:201], v[58:59], v[248:249] op_sel:[0,0,0] op_sel_hi:[1,0,1]
    v_pk_fma_f32 v[250:251], v[202:203], v[58:59], v[250:251] op_sel:[0,0,0] op_sel_hi:[1,0,1]
    v_pk_fma_f32 v[252:253], v[204:205], v[58:59], v[252:253] op_sel:[0,0,0] op_sel_hi:[1,0,1]
    v_pk_fma_f32 v[254:255], v[206:207], v[58:59], v[254:255] op_sel:[0,0,0] op_sel_hi:[1,0,1]
    v_pk_fma_f32 v[248:249], v[216:217], v[58:59], v[248:249] op_sel:[0,1,0] op_sel_hi:[1,1,1]
    v_pk_fma_f32 v[250:251], v[218:219], v[58:59], v[250:251] op_sel:[0,1,0] op_sel_hi:[1,1,1]
    v_pk_fma_f32 v[252:253], v[220:221], v[58:59], v[252:253] op_sel:[0,1,0] op_sel_hi:[1,1,1]
    v_pk_fma_f32 v[254:255], v[222:223], v[58:59], v[254:255] op_sel:[0,1,0] op_sel_hi:[1,1,1]
    v_cvt_pk_bf16_f32 v44, v248, v249
    v_cvt_pk_bf16_f32 v46, v252, v253
    v_cvt_pk_bf16_f32 v45, v250, v251
    v_cvt_pk_bf16_f32 v47, v254, v255
    s_nop 0
    v_permlane32_swap_b32 v44, v46
    v_permlane32_swap_b32 v45, v47
    buffer_store_dwordx4 v[44:47], v124, s[36:39], s23 offen offset:32
L_end:
    s_endpgm
L_slow:
    s_waitcnt lgkmcnt(0)
    s_barrier
    s_mov_b32 s40, 1
    s_mov_b32 s16, s26
    s_mov_b32 s17, 0
L_slow_loop:
    s_mov_b32 m0, s25
    s_nop 0
    buffer_load_dwordx4 v108, s[28:31], s16 offen offset:0 lds
    buffer_load_dwordx4 v109, s[28:31], s16 offen offset:1024 lds
    buffer_load_dwordx4 v110, s[28:31], s16 offen offset:2048 lds
    buffer_load_dwordx4 v111, s[28:31], s16 offen offset:3072 lds
    s_add_u32 m0, s25, 4096
    s_add_u32 s16, s16, 4096
    buffer_load_dwordx4 v108, s[28:31], s16 offen offset:0 lds
    buffer_load_dwordx4 v109, s[28:31], s16 offen offset:1024 lds
    buffer_load_dwordx4 v110, s[28:31], s16 offen offset:2048 lds
    buffer_load_dwordx4 v111, s[28:31], s16 offen offset:3072 lds
    s_add_u32 s16, s16, 28672
    s_waitcnt vmcnt(0)
    ds_read_b128 a[192:195], v96
    ds_read_b128 a[196:199], v97
    ds_read_b128 a[200:203], v98
    ds_read_b128 a[204:207], v99
    ds_read_b128 a[208:211], v100
    ds_read_b128 a[212:215], v101
    ds_read_b128 a[216:219], v102
    ds_read_b128 a[220:223], v103
    s_waitcnt lgkmcnt(0)
    v_mfma_f32_32x32x16_bf16 v[16:31], a[192:195], a[128:131], 0
    v_mfma_f32_32x32x16_bf16 v[16:31], a[196:199], a[132:135], v[16:31]
    v_mfma_f32_32x32x16_bf16 v[16:31], a[200:203], a[136:139], v[16:31]
    v_mfma_f32_32x32x16_bf16 v[16:31], a[204:207], a[140:143], v[16:31]
    v_mfma_f32_32x32x16_bf16 v[16:31], a[208:211], a[144:147], v[16:31]
    v_mfma_f32_32x32x16_bf16 v[16:31], a[212:215], a[148:151], v[16:31]
    v_mfma_f32_32x32x16_bf16 v[16:31], a[216:219], a[152:155], v[16:31]
    v_mfma_f32_32x32x16_bf16 v[16:31], a[220:223], a[156:159], v[16:31]
    v_mfma_f32_32x32x16_bf16 v[32:47], a[192:195], a[160:163], 0
    v_mfma_f32_32x32x16_bf16 v[32:47], a[196:199], a[164:167], v[32:47]
    v_mfma_f32_32x32x16_bf16 v[32:47], a[200:203], a[168:171], v[32:47]
    v_mfma_f32_32x32x16_bf16 v[32:47], a[204:207], a[172:175], v[32:47]
    v_mfma_f32_32x32x16_bf16 v[32:47], a[208:211], a[176:179], v[32:47]
    v_mfma_f32_32x32x16_bf16 v[32:47], a[212:215], a[180:183], v[32:47]
    v_mfma_f32_32x32x16_bf16 v[32:47], a[216:219], a[184:187], v[32:47]
    v_mfma_f32_32x32x16_bf16 v[32:47], a[220:223], a[188:191], v[32:47]
    s_nop 15
    v_max3_f32 v118, v16, v17, v118
    v_max3_f32 v118, v18, v19, v118
    v_max3_f32 v118, v20, v21, v118
    v_max3_f32 v118, v22, v23, v118
    v_max3_f32 v118, v24, v25, v118
    v_max3_f32 v118, v26, v27, v118
    v_max3_f32 v118, v28, v29, v118
    v_max3_f32 v118, v30, v31, v118
    v_max3_f32 v119, v32, v33, v119
    v_max3_f32 v119, v34, v35, v119
    v_max3_f32 v119, v36, v37, v119
    v_max3_f32 v119, v38, v39, v119
    v_max3_f32 v119, v40, v41, v119
    v_max3_f32 v119, v42, v43, v119
    v_max3_f32 v119, v44, v45, v119
    v_max3_f32 v119, v46, v47, v119
    s_add_u32 s17, s17, 1
    s_cmp_lt_u32 s17, 8
    s_cbranch_scc1 L_slow_loop
    s_branch L_restart
.section .rodata,"a"
.p2align 6
.amdhsa_kernel standalone__gqa_softmax__near_ridge_kernel
  .amdhsa_next_free_vgpr 512
  .amdhsa_next_free_sgpr 102
  .amdhsa_accum_offset 256
  .amdhsa_group_segment_fixed_size 0
  .amdhsa_kernarg_size 48
  .amdhsa_user_sgpr_count 2
  .amdhsa_user_sgpr_kernarg_segment_ptr 1
  .amdhsa_system_sgpr_workgroup_id_x 1
.end_amdhsa_kernel
```
